```python
import torch

def _softmax(x, axis=-1):
    return torch.softmax(x, dim=axis)

def _gelu(x):
    return torch.nn.functional.gelu(x, approximate='tanh')

def _silu(x):
    return torch.nn.functional.silu(x)

def _sigmoid(x):
    return torch.sigmoid(x)

def _layernorm(x, axis=-1, eps=1e-05):
    m = x.mean(dim=axis, keepdim=True)
    v = x.var(dim=axis, keepdim=True, unbiased=False)
    return (x - m) / torch.sqrt(v + eps)

def _scatter_add(tgt, idx, src, axis=0):
    return tgt.clone().index_add_(axis, idx, src)

def _segment_sum(src, seg, n):
    out = torch.zeros((n,) + src.shape[1:], dtype=src.dtype)
    return out.index_add_(0, seg, src)

def _pad(x, pw):
    flat = tuple((v for pair in reversed(pw) for v in pair))
    return torch.nn.functional.pad(x, flat)
kernel_name = 'standalone__tensor_product_equiv_tfn__graph'

def setup_inputs():

    _w = lambda a: (lambda t: t.to(torch.bfloat16) if t.is_floating_point() else t)(torch.as_tensor(a))
    N, deg, C, L, DE = (10000, 64, 64, 1, 16)
    E = N * deg
    M = (L + 1) ** 2
    src = (lambda lo, hi, *s: torch.randint(lo, hi, s))(0, N, E).to(torch.int64)
    dst = (lambda lo, hi, *s: torch.randint(lo, hi, s))(0, N, E).to(torch.int64)
    r = (lambda *s: torch.randn(*s, dtype=torch.bfloat16) * 0.05)(E, 3)
    r = r / (torch.linalg.norm(r, dim=-1, keepdim=True) + 1e-09)
    rx, ry, rz = (r[:, 0].clone(), r[:, 1].clone(), r[:, 2].clone())
    Ys = [torch.ones((E, 1), dtype=float)]
    if L >= 1:
        Ys.append(r.to(float))
    if L >= 2:
        Ys.append(torch.stack([2 * rx * ry, 2 * ry * rz, (3 * rz * rz - 1.0) / (lambda _x: torch.sqrt(torch.as_tensor(_x)))(3.0), 2 * rx * rz, rx * rx - ry * ry], dim=-1).to(float))
    for _l in range(3, L + 1):
        Ys.append(((lambda *s: torch.randn(*s, dtype=torch.bfloat16) * 0.05)(E, 2 * _l + 1) * 0.3).to(float))
    Y = torch.cat(Ys, dim=-1)
    cg = torch.zeros((M, M, M), dtype=float)
    off = [_l * _l for _l in range(L + 2)]
    for l1 in range(L + 1):
        for l2 in range(L + 1):
            for l3 in range(abs(l1 - l2), min(L, l1 + l2) + 1):
                d1, d2, d3 = (2 * l1 + 1, 2 * l2 + 1, 2 * l3 + 1)
                cg[off[l1]:off[l1 + 1], off[l2]:off[l2 + 1], off[l3]:off[l3 + 1]] = (lambda *s: torch.randn(*s, dtype=torch.bfloat16) * 0.05)(d1, d2, d3) / (lambda _x: torch.sqrt(torch.as_tensor(_x)))(float(d1 * d2))
    return {'x': _w((lambda *s: torch.randn(*s, dtype=torch.bfloat16) * 0.05)(N, C, M) * 0.2), 'src': _w(src), 'dst': _w(dst), 'Y': _w(Y), 'edge_feat': _w((lambda *s: torch.randn(*s, dtype=torch.bfloat16) * 0.05)(E, DE)), 'w_rad': _w((lambda *s: torch.randn(*s, dtype=torch.bfloat16) * 0.05)(DE, C) * (1.0 / max(1.0, DE) ** 0.5)), 'cg': _w(cg), 'w_mix': _w((lambda *s: torch.randn(*s, dtype=torch.bfloat16) * 0.05)(C, C) * (1.0 / max(1.0, C) ** 0.5))}

def reference(x, src, dst, Y, edge_feat, w_rad, cg, w_mix):
    N, C, M = (x.shape[0], x.shape[1], x.shape[2])
    R = _silu(edge_feat @ w_rad)
    xs = x[src]
    tp = torch.einsum('eci,ef,ifo->eco', xs, Y, cg)
    msg = R[:, :, None] * tp
    agg = _segment_sum(msg.reshape(-1, C * M), dst, N).reshape(N, C, M)
    return torch.einsum('ncm,cd->ndm', agg, w_mix)
```

```asm
; @launch grid=(256,1,1) block=(1024,1,1) lds=163200
.amdgcn_target "amdgcn-amd-amdhsa--gfx950"
.text
.globl standalone__tensor_product_equiv_tfn__graph_kernel
.p2align 8
.type standalone__tensor_product_equiv_tfn__graph_kernel,@function
standalone__tensor_product_equiv_tfn__graph_kernel:
    s_cmp_ge_u32 s2, 256
    s_cbranch_scc1 K_END
    s_load_dwordx16 s[32:47], s[0:1], 0
    s_load_dwordx2 s[16:17], s[0:1], 80
    s_load_dwordx2 s[12:13], s[0:1], 64
    s_load_dwordx2 s[58:59], s[0:1], 72
    v_lshrrev_b32 v112, 6, v0
    v_and_b32 v113, 63, v0
    v_readfirstlane_b32 s19, v112
    s_mul_i32 s29, s2, 10000
    s_mul_i32 s31, s2, 20000
    v_lshl_add_u32 v114, v0, 4, s29
    v_lshl_add_u32 v115, v0, 5, s31
    s_movk_i32 s30, 625
    v_cmp_gt_u32 s[60:61], s30, v0
    v_mov_b64 v[64:65], 0
    v_mov_b64 v[66:67], 0
    v_and_b32 v112, 0xff, v0
    v_lshlrev_b32 v112, 2, v112
    ds_write_b32 v112, v64 offset:0
    s_cmp_ge_u32 s19, 10
    s_cbranch_scc1 KA_AUX0
    s_mov_b64 exec, s[60:61]
    s_waitcnt lgkmcnt(0)
    global_load_dwordx4 v[32:35], v114, s[36:37]
    s_barrier
    global_load_dwordx4 v[36:39], v114, s[34:35]
    global_load_dwordx4 v[40:43], v115, s[38:39]
    global_load_dwordx4 v[44:47], v115, s[38:39] offset:16
    s_mov_b64 exec, -1
    s_branch KA_JOIN0
KA_AUX0:
    s_cmp_eq_u32 s19, 10
    s_cbranch_scc0 KA_NOCODE
    s_getpc_b64 s[62:63]
KA_PC:
    s_lshr_b32 s3, s2, 3
    s_mul_i32 s3, s3, ((K_END - KA_PC) / 128 + 32) / 32
    v_min_u32 v116, 4, v113
    v_add_u32 v116, s3, v116
    v_min_u32 v116, (K_END - KA_PC) / 128, v116
    v_lshlrev_b32 v116, 7, v116
    global_load_dword v127, v116, s[62:63]
KA_NOCODE:
    s_waitcnt lgkmcnt(0)
    s_cmp_eq_u32 s19, 15
    s_cbranch_scc0 KA_NOTAG
    s_cmp_eq_u32 s2, 0
    s_cbranch_scc0 KA_NOTAG
    s_memrealtime s[62:63]
    s_waitcnt lgkmcnt(0)
    s_lshl_b32 s63, s63, 24
    s_or_b32 s63, s63, 1
    v_mov_b32 v32, s63
    v_mov_b32 v33, s62
    s_mov_b64 exec, 1
    global_store_dwordx2 v64, v[32:33], s[58:59] sc1
    s_mov_b64 exec, -1
KA_NOTAG:
    s_barrier
KA_JOIN0:
    s_and_b32 s18, s2, 7
    s_lshl_b32 s18, s18, 5
    s_lshr_b32 s3, s2, 3
    s_add_u32 s18, s18, s3
    s_sub_u32 s4, s32, 512
    s_subb_u32 s5, s33, 0
    s_and_b32 s5, s5, 0xffff
    s_or_b32 s5, s5, 0x100000
    s_mov_b32 s6, 64
    s_mov_b32 s7, 0x800000
    s_mov_b32 s52, s32
    s_and_b32 s53, s33, 0xffff
    s_mov_b32 s54, 5120000
    s_mov_b32 s55, 0x20000
    s_mov_b32 s8, s40
    s_and_b32 s9, s41, 0xffff
    s_mov_b32 s10, 20480000
    s_mov_b32 s11, 0x20000
    s_and_b32 s13, s13, 0xffff
    s_mov_b32 s14, 5120000
    s_mov_b32 s15, 0x20000
    s_mov_b32 s20, 0
    s_mov_b32 s21, 2
    s_lshr_b32 s3, s18, 2
    s_lshl_b32 s3, s3, 4
    s_and_b32 s29, s18, 1
    s_lshl_b32 s29, s29, 3
    s_add_u32 s3, s3, s29
    s_and_b32 s29, s18, 2
    s_lshl_b32 s29, s29, 9
    s_add_u32 s3, s3, s29
    s_add_u32 s3, s3, 7766016
    v_lshrrev_b32 v114, 4, v0
    v_lshlrev_b32 v114, 2, v114
    v_and_or_b32 v115, v0, 3, v114
    v_lshl_add_u32 v14, v115, 11, s3
    v_and_b32 v116, 31, v113
    v_lshrrev_b32 v117, 5, v113
    v_lshlrev_b32 v3, 4, v117
    v_lshlrev_b32 v4, 3, v116
    v_add_u32 v4, 73984, v4
    v_and_b32 v118, 15, v0
    v_add_lshl_u32 v5, v118, v3, 2
    v_lshrrev_b32 v118, 3, v116
    v_lshlrev_b32 v118, 2, v118
    v_and_or_b32 v118, v116, 3, v118
    v_lshlrev_b32 v118, 2, v118
    v_and_b32 v112, 4, v116
    v_lshl_add_u32 v6, v112, 4, v118
    v_lshrrev_b32 v118, 2, v116
    v_and_b32 v112, 1, v116
    v_lshl_add_u32 v118, v112, 3, v118
    v_add_lshl_u32 v7, v118, v3, 2
    v_mov_b32 v8, 1
    v_mov_b32 v9, 2048
    s_cmp_ge_u32 s19, 10
    s_cbranch_scc1 KA_AUX1
    s_mov_b64 exec, s[60:61]
    v_lshlrev_b32 v112, 2, v0
    v_add_u32 v112, 4096, v112
    s_movk_i32 s31, -2500
    s_waitcnt vmcnt(3)
    v_add_u32 v114, 6400, v32
    v_lshrrev_b32 v114, 12, v114
    v_and_or_b32 v114, v114, 4, 2
    v_lshlrev_b32_sdwa v48, v114, v32 dst_sel:DWORD dst_unused:UNUSED_PAD src0_sel:DWORD src1_sel:BYTE_0
    ds_add_rtn_u32 v52, v48, v8 offset:0
    v_add_u32 v114, 6400, v33
    v_lshrrev_b32 v114, 12, v114
    v_and_or_b32 v114, v114, 4, 2
    v_lshlrev_b32_sdwa v49, v114, v33 dst_sel:DWORD dst_unused:UNUSED_PAD src0_sel:DWORD src1_sel:BYTE_0
    ds_add_rtn_u32 v53, v49, v8 offset:0
    v_add_u32 v114, 6400, v34
    v_lshrrev_b32 v114, 12, v114
    v_and_or_b32 v114, v114, 4, 2
    v_lshlrev_b32_sdwa v50, v114, v34 dst_sel:DWORD dst_unused:UNUSED_PAD src0_sel:DWORD src1_sel:BYTE_0
    ds_add_rtn_u32 v54, v50, v8 offset:0
    v_add_u32 v114, 6400, v35
    v_lshrrev_b32 v114, 12, v114
    v_and_or_b32 v114, v114, 4, 2
    v_lshlrev_b32_sdwa v51, v114, v35 dst_sel:DWORD dst_unused:UNUSED_PAD src0_sel:DWORD src1_sel:BYTE_0
    ds_add_rtn_u32 v55, v51, v8 offset:0
    s_waitcnt lgkmcnt(0)
    s_barrier
    v_lshrrev_b32 v32, 8, v32
    v_or_b32 v115, 0, v112
    v_lshl_or_b32 v32, v32, 24, v115
    v_lshrrev_b32 v33, 8, v33
    v_or_b32 v115, 1, v112
    v_lshl_or_b32 v33, v33, 24, v115
    v_lshrrev_b32 v34, 8, v34
    v_or_b32 v115, 2, v112
    v_lshl_or_b32 v34, v34, 24, v115
    v_lshrrev_b32 v35, 8, v35
    v_or_b32 v115, 3, v112
    v_lshl_or_b32 v35, v35, 24, v115
    s_barrier
    ds_read_b32 v48, v48 offset:1024
    ds_read_b32 v49, v49 offset:1024
    ds_read_b32 v50, v50 offset:1024
    ds_read_b32 v51, v51 offset:1024
    s_waitcnt lgkmcnt(3)
    v_add_lshl_u32 v48, v48, v52, 2
    v_add_u32 v52, v48, v48
    s_waitcnt lgkmcnt(2)
    v_add_lshl_u32 v49, v49, v53, 2
    v_add_u32 v53, v49, v49
    s_waitcnt lgkmcnt(1)
    v_add_lshl_u32 v50, v50, v54, 2
    v_add_u32 v54, v50, v50
    s_waitcnt lgkmcnt(0)
    v_add_lshl_u32 v51, v51, v55, 2
    v_add_u32 v55, v51, v51
    s_waitcnt vmcnt(2)
    v_mul_u32_u24 v114, 6710, v36
    v_lshrrev_b32 v114, 24, v114
    v_mad_i32_i24 v36, v114, s31, v36
    v_lshl_or_b32 v36, v114, 18, v36
    v_lshl_add_u32 v32, v36, 12, v32
    ds_write_b32 v48, v32 offset:10496
    v_mul_u32_u24 v114, 6710, v37
    v_lshrrev_b32 v114, 24, v114
    v_mad_i32_i24 v37, v114, s31, v37
    v_lshl_or_b32 v37, v114, 18, v37
    v_lshl_add_u32 v33, v37, 12, v33
    ds_write_b32 v49, v33 offset:10496
    v_mul_u32_u24 v114, 6710, v38
    v_lshrrev_b32 v114, 24, v114
    v_mad_i32_i24 v38, v114, s31, v38
    v_lshl_or_b32 v38, v114, 18, v38
    v_lshl_add_u32 v34, v38, 12, v34
    ds_write_b32 v50, v34 offset:10496
    v_mul_u32_u24 v114, 6710, v39
    v_lshrrev_b32 v114, 24, v114
    v_mad_i32_i24 v39, v114, s31, v39
    v_lshl_or_b32 v39, v114, 18, v39
    v_lshl_add_u32 v35, v39, 12, v35
    ds_write_b32 v51, v35 offset:10496
    s_waitcnt vmcnt(1)
    ds_write_b64 v52, v[40:41] offset:20608
    ds_write_b64 v53, v[42:43] offset:20608
    s_waitcnt vmcnt(0)
    ds_write_b64 v54, v[44:45] offset:20608
    ds_write_b64 v55, v[46:47] offset:20608
    s_mov_b64 exec, -1
    s_branch KA_JOIN3
KA_AUX1:
    s_cmp_eq_u32 s19, 15
    s_cbranch_scc1 KA_SCAN
    s_and_b32 s64, s19, 1
    s_lshl_b32 s63, s64, 6
    s_lshl_b32 s65, s64, 1
    s_cmp_lt_u32 s19, 12
    s_cselect_b64 s[66:67], s[42:43], s[44:45]
    s_cselect_b32 s65, s65, s63
    s_cselect_b32 s68, 5, 6
    s_cselect_b32 s69, 31, 3
    s_cselect_b32 s70, 2, 1
    s_cselect_b32 s71, 128, 8
    s_cselect_b32 s72, 0, 128
    s_add_u32 s63, s63, s72
    v_lshrrev_b32 v114, s68, v113
    v_lshlrev_b32 v114, 10, v114
    v_and_b32 v115, s69, v113
    v_lshlrev_b32 v115, s70, v115
    v_add3_u32 v114, v114, v115, s65
    v_lshrrev_b32 v115, 4, v113
    v_lshlrev_b32 v115, 11, v115
    v_and_b32 v116, 15, v113
    v_lshlrev_b32 v116, 2, v116
    v_add3_u32 v115, v115, v116, s63
    s_barrier
    s_barrier
    s_cmp_lt_u32 s19, 14
    s_cbranch_scc0 KA_JOIN3
    global_load_ushort v40, v114, s[66:67]
    v_add_u32 v114, s71, v114
    global_load_ushort v41, v114, s[66:67]
    v_add_u32 v114, s71, v114
    global_load_ushort v42, v114, s[66:67]
    v_add_u32 v114, s71, v114
    global_load_ushort v43, v114, s[66:67]
    v_add_u32 v114, s71, v114
    global_load_ushort v44, v114, s[66:67]
    v_add_u32 v114, s71, v114
    global_load_ushort v45, v114, s[66:67]
    v_add_u32 v114, s71, v114
    global_load_ushort v46, v114, s[66:67]
    v_add_u32 v114, s71, v114
    global_load_ushort v47, v114, s[66:67]
    v_add_u32 v114, s71, v114
    global_load_dword v68, v115, s[46:47] offset:0
    global_load_dword v69, v115, s[46:47] offset:256
    global_load_dword v70, v115, s[46:47] offset:512
    global_load_dword v71, v115, s[46:47] offset:768
    global_load_dword v72, v115, s[46:47] offset:1024
    global_load_dword v73, v115, s[46:47] offset:1280
    global_load_dword v74, v115, s[46:47] offset:1536
    global_load_dword v75, v115, s[46:47] offset:1792
    s_branch KA_JOIN3
KA_SCAN:
    v_lshlrev_b32 v115, 4, v113
    s_setprio 3
    s_barrier
    ds_read_b128 v[56:59], v115 offset:0
    s_waitcnt lgkmcnt(0)
    v_add_u32 v54, v56, v57
    v_add_u32 v55, v54, v58
    v_add_u32 v52, v55, v59
    v_add_u32 v116, v55, v59
    s_nop 1
    v_add_u32_dpp v116, v116, v116 row_shr:1 row_mask:0xf bank_mask:0xf bound_ctrl:0
    s_nop 1
    v_add_u32_dpp v116, v116, v116 row_shr:2 row_mask:0xf bank_mask:0xf bound_ctrl:0
    s_nop 1
    v_add_u32_dpp v116, v116, v116 row_shr:4 row_mask:0xf bank_mask:0xf bound_ctrl:0
    s_nop 1
    v_add_u32_dpp v116, v116, v116 row_shr:8 row_mask:0xf bank_mask:0xf bound_ctrl:0
    s_nop 1
    v_add_u32_dpp v116, v116, v116 row_bcast:15 row_mask:0xa bank_mask:0xf
    s_nop 1
    v_add_u32_dpp v116, v116, v116 row_bcast:31 row_mask:0xc bank_mask:0xf
    v_sub_u32 v52, v116, v52
    v_add_u32 v53, v52, v56
    v_add_u32 v54, v52, v54
    v_add_u32 v55, v52, v55
    ds_write_b128 v115, v[52:55] offset:1024
    s_waitcnt lgkmcnt(0)
    s_barrier
    s_setprio 0
    global_load_dwordx2 v[48:49], v64, s[58:59] sc1
    v_lshl_or_b32 v56, v56, 12, v52
    v_lshl_or_b32 v57, v57, 12, v53
    v_lshl_or_b32 v58, v58, 12, v54
    v_lshl_or_b32 v59, v59, 12, v55
KA_JOIN3:
    v_lshlrev_b32 v114, 4, v0
    s_mul_i32 s29, s2, 30336
    v_add_u32 v115, s29, v114
    v_add_u32 v116, 16384, v115
    v_cmp_gt_u32 vcc, 858, v0
    v_and_b32 v112, 0xff, v0
    v_lshlrev_b32 v112, 2, v112
    v_mov_b32 v117, 16
    v_lshlrev_b32 v118, 4, v113
    s_waitcnt lgkmcnt(0)
    s_barrier
    ds_read_b128 v[32:35], v114 offset:10496
    ds_read_b128 v[36:39], v114 offset:26880
    s_waitcnt lgkmcnt(1)
    global_store_dwordx4 v115, v[32:35], s[16:17] sc1
    s_and_saveexec_b64 s[60:61], vcc
    s_cbranch_execz KA_NOST2
    s_waitcnt lgkmcnt(0)
    global_store_dwordx4 v116, v[36:39], s[16:17] sc1
KA_NOST2:
    s_mov_b64 exec, -1
    ds_write_b32 v112, v64 offset:0
    ds_write2_b32 v9, v117, v64 offset0:0 offset1:1
    v_add_u32 v115, 73984, v114
    v_add_u32 v116, 146816, v114
    ds_write_b128 v115, v[64:67] offset:0
    ds_write_b128 v115, v[64:67] offset:16384
    ds_write_b128 v115, v[64:67] offset:32768
    ds_write_b128 v115, v[64:67] offset:49152
    v_add_u32 v115, 65536, v115
    ds_write_b128 v116, v[64:67]
    ds_write_b128 v115, v[64:67]
    s_mov_b32 s31, 262144
    s_lshl_b32 s3, s2, 11
    s_add_u32 s3, s3, 7766016
    v_add_u32 v60, s3, v118
    s_cmp_lt_u32 s19, 10
    s_cbranch_scc1 KA_JOIN4
    s_cmp_eq_u32 s19, 15
    s_cbranch_scc1 KA_TAG
    s_cmp_eq_u32 s19, 14
    s_cbranch_scc1 KA_JOIN4
    s_cmp_lt_u32 s19, 12
    s_cselect_b32 s62, 0xbfb8aa3b, 1.0
    s_mov_b32 s63, 0x05040100
    s_mov_b32 s64, 0x07060302
    s_sub_u32 s65, s19, 10
    s_lshl_b32 s65, s65, 11
    v_add_u32 v115, s65, v118
    s_waitcnt vmcnt(2)
    v_lshlrev_b32 v40, 16, v40
    v_mul_f32 v40, s62, v40
    v_lshlrev_b32 v41, 16, v41
    v_mul_f32 v41, s62, v41
    v_lshlrev_b32 v42, 16, v42
    v_mul_f32 v42, s62, v42
    v_lshlrev_b32 v43, 16, v43
    v_mul_f32 v43, s62, v43
    v_lshlrev_b32 v44, 16, v44
    v_mul_f32 v44, s62, v44
    v_lshlrev_b32 v45, 16, v45
    v_mul_f32 v45, s62, v45
    v_lshlrev_b32 v46, 16, v46
    v_mul_f32 v46, s62, v46
    v_lshlrev_b32 v47, 16, v47
    v_mul_f32 v47, s62, v47
    v_cvt_pk_bf16_f32 v48, v40, v41
    v_cvt_pk_bf16_f32 v49, v42, v43
    v_cvt_pk_bf16_f32 v50, v44, v45
    v_cvt_pk_bf16_f32 v51, v46, v47
    v_perm_b32 v52, v69, v68, s63
    v_perm_b32 v56, v69, v68, s64
    v_perm_b32 v53, v71, v70, s63
    v_perm_b32 v57, v71, v70, s64
    v_perm_b32 v54, v73, v72, s63
    v_perm_b32 v58, v73, v72, s64
    v_perm_b32 v55, v75, v74, s63
    v_perm_b32 v59, v75, v74, s64
    ds_write_b128 v114, v[48:51] offset:33024
    ds_write_b128 v115, v[52:55] offset:2304
    ds_write_b128 v115, v[56:59] offset:3328
    s_branch KA_JOIN4
KA_TAG:
    s_waitcnt vmcnt(1)
KA_TAG1:
    v_cmp_eq_u32 vcc, 0, v48
    s_cbranch_vccz KA_GOTTAG
    s_sub_u32 s31, s31, 1
    s_cbranch_scc1 K_END
    global_load_dwordx2 v[48:49], v64, s[58:59] sc1
    s_waitcnt vmcnt(0)
    s_branch KA_TAG1
KA_GOTTAG:
    v_and_b32 v48, 0xff000000, v48
    ds_write_b64 v9, v[48:49] offset:8
    v_or_b32 v40, v56, v48
    v_mov_b32 v41, v49
    v_or_b32 v42, v57, v48
    v_mov_b32 v43, v49
    v_or_b32 v44, v58, v48
    v_mov_b32 v45, v49
    v_or_b32 v46, v59, v48
    v_mov_b32 v47, v49
KA_JOIN4:
    s_waitcnt vmcnt(0) lgkmcnt(0)
    s_barrier
    s_cmp_eq_u32 s19, 15
    s_cbranch_scc0 KA_PUBD
    global_store_dwordx4 v60, v[40:43], s[16:17] sc1
    global_store_dwordx4 v60, v[44:47], s[16:17] offset:1024 sc1
KA_PUBD:
    s_lshr_b32 s29, s2, 3
    s_mul_i32 s29, s29, 10240
    s_add_u32 s29, s29, 0
    s_getreg_b32 s3, hwreg(HW_REG_XCC_ID, 0, 3)
    s_lshl_b32 s3, s3, 1
    s_lshr_b32 s3, 0xe4e4, s3
    s_and_b32 s3, s3, 3
    s_mul_i32 s3, s3, 1280000
    s_add_u32 s29, s29, s3
    v_cmp_gt_u32 vcc, 80, v0
    v_lshl_add_u32 v117, v0, 7, s29
    s_and_saveexec_b64 s[60:61], vcc
    s_cbranch_execz XT_0
    buffer_load_dword v127, v117, s[52:55], 0 offen
XT_0:
    s_mov_b64 exec, -1
    ds_read_b64 v[48:49], v9 offset:8
    ds_read_b128 v[16:19], v118 offset:43264
    ds_read_b128 v[20:23], v118 offset:44288
    ds_read_b128 v[24:27], v118 offset:45312
    ds_read_b128 v[28:31], v118 offset:46336
    v_and_b32 v115, 15, v0
    s_add_u32 s29, s21, 3
    v_lshrrev_b32 v116, s29, v115
    v_lshl_add_u32 v115, v116, 20, v115
    v_add_u32 v115, s20, v115
    v_lshrrev_b32 v92, 4, v0
    v_mul_u32_u24 v92, 121344, v92
    v_add_u32 v93, 30336, v92
    v_add_u32 v94, 60672, v92
    v_add_u32 v95, 91008, v92
    s_waitcnt vmcnt(0) lgkmcnt(0)
    s_barrier
KA_POLL:
    global_load_dwordx2 v[32:33], v14, s[16:17] sc1
    s_waitcnt vmcnt(0)
KA_POLL1:
    v_mov_b32 v2, v32
    v_and_b32 v32, 0xff000000, v32
    v_cmp_ne_u64 vcc, v[32:33], v[48:49]
    s_cbranch_vccz KA_READY
    s_mov_b64 exec, vcc
    s_sub_u32 s31, s31, 1
    s_cbranch_scc1 K_END
    s_branch KA_POLL
KA_READY:
    s_mov_b64 exec, -1
    v_and_b32 v1, 0xfff, v2
    v_bfe_u32 v2, v2, 12, 12
KB_ROUND0:
    s_cmp_eq_u32 s21, 2
    s_cselect_b32 s31, 16, 0x7fffffff
    v_sub_u32_dpp v64, v2, v115 row_newbcast:0 row_mask:0xf bank_mask:0xf
    v_add_u32_dpp v72, v1, v115 row_newbcast:0 row_mask:0xf bank_mask:0xf
    v_cmp_lt_i32 s[32:33], 0, v64
    v_lshl_add_u32 v76, v72, 2, v92
    s_mov_b64 exec, s[32:33]
    global_load_dword v34, v76, s[16:17] sc1
    s_mov_b64 exec, -1
    v_sub_u32_dpp v65, v2, v115 row_newbcast:1 row_mask:0xf bank_mask:0xf
    v_add_u32_dpp v73, v1, v115 row_newbcast:1 row_mask:0xf bank_mask:0xf
    v_cmp_lt_i32 s[34:35], 0, v65
    v_lshl_add_u32 v77, v73, 2, v93
    s_mov_b64 exec, s[34:35]
    global_load_dword v38, v77, s[16:17] sc1
    s_mov_b64 exec, -1
    v_sub_u32_dpp v66, v2, v115 row_newbcast:2 row_mask:0xf bank_mask:0xf
    v_add_u32_dpp v74, v1, v115 row_newbcast:2 row_mask:0xf bank_mask:0xf
    v_cmp_lt_i32 s[36:37], 0, v66
    v_lshl_add_u32 v78, v74, 2, v94
    s_mov_b64 exec, s[36:37]
    global_load_dword v42, v78, s[16:17] sc1
    s_mov_b64 exec, -1
    v_sub_u32_dpp v67, v2, v115 row_newbcast:3 row_mask:0xf bank_mask:0xf
    v_add_u32_dpp v75, v1, v115 row_newbcast:3 row_mask:0xf bank_mask:0xf
    v_cmp_lt_i32 s[38:39], 0, v67
    v_lshl_add_u32 v79, v75, 2, v95
    s_mov_b64 exec, s[38:39]
    global_load_dword v46, v79, s[16:17] sc1
    s_mov_b64 exec, -1
    v_cmp_lt_i32 s[40:41], s31, v64
    v_cmp_lt_i32 s[42:43], s31, v65
    v_cmp_lt_i32 s[44:45], s31, v66
    v_cmp_lt_i32 s[46:47], s31, v67
    v_lshl_add_u32 v72, v72, 3, v92
    v_lshl_add_u32 v73, v73, 3, v93
    v_lshl_add_u32 v74, v74, 3, v94
    v_lshl_add_u32 v75, v75, 3, v95
    s_lshl_b32 s29, 8, s21
    s_add_u32 s29, s29, s20
    v_cmp_lt_u32 s[26:27], s29, v2
    s_add_u32 s56, s16, 10112
    s_addc_u32 s57, s17, 0
    s_or_b64 s[48:49], s[40:41], s[42:43]
    s_or_b64 s[48:49], s[48:49], s[44:45]
    s_or_b64 s[48:49], s[48:49], s[46:47]
    s_cbranch_scc0 KB_NOSEC_A
    s_mov_b64 exec, s[40:41]
    s_cbranch_execz KB_SA0
    global_load_dword v50, v76, s[16:17] offset:64 sc1
    global_load_dwordx2 v[48:49], v72, s[56:57] offset:128 sc1
KB_SA0:
    s_mov_b64 exec, s[42:43]
    s_cbranch_execz KB_SA1
    global_load_dword v54, v77, s[16:17] offset:64 sc1
    global_load_dwordx2 v[52:53], v73, s[56:57] offset:128 sc1
KB_SA1:
    s_mov_b64 exec, s[44:45]
    s_cbranch_execz KB_SA2
    global_load_dword v58, v78, s[16:17] offset:64 sc1
    global_load_dwordx2 v[56:57], v74, s[56:57] offset:128 sc1
KB_SA2:
    s_mov_b64 exec, s[46:47]
    s_cbranch_execz KB_SA3
    global_load_dword v62, v79, s[16:17] offset:64 sc1
    global_load_dwordx2 v[60:61], v75, s[56:57] offset:128 sc1
KB_SA3:
    s_mov_b64 exec, -1
KB_NOSEC_A:
    s_cmp_eq_u64 s[26:27], 0
    s_cbranch_scc1 KB_NOMORE
    ds_write_b32 v9, v8 offset:4
KB_NOMORE:
    v_lshrrev_b32 v80, 4, v0
    v_mul_u32_u24 v80, 10000, v80
    v_add_u32 v81, 2500, v80
    v_add_u32 v82, 5000, v80
    v_add_u32 v83, 7500, v80
    s_getreg_b32 s3, hwreg(HW_REG_XCC_ID, 0, 3)
    s_lshl_b32 s3, s3, 1
    s_lshr_b32 s3, 0xe4e4, s3
    s_and_b32 s3, s3, 3
    s_lshl_b32 s3, s3, 8
    v_and_b32 v113, 63, v0
    v_lshl_add_u32 v114, v113, 4, s3
    v_and_b32 v114, 0x3ff, v114
    v_mov_b32 v117, 4
    v_mov_b32 v118, 0x3f000fff
    v_mov_b32 v115, 2096640
    s_lshl_b32 s29, s19, 7
    v_add_u32 v12, s29, v6
    v_add_u32 v11, s29, v5
    v_add_lshl_u32 v15, s29, v7, 1
    v_lshl_add_u32 v13, v3, 2, s29
    s_movk_i32 s30, 2176
    v_mov_b32 v10, 87040
    s_mov_b32 s0, 1280000
    s_waitcnt vmcnt(0)
    s_or_b64 exec, s[32:33], 1
    global_load_dwordx2 v[32:33], v72, s[56:57] sc1
    s_or_b64 exec, s[34:35], 1
    global_load_dwordx2 v[36:37], v73, s[56:57] sc1
    s_or_b64 exec, s[36:37], 1
    global_load_dwordx2 v[40:41], v74, s[56:57] sc1
    s_or_b64 exec, s[38:39], 1
    global_load_dwordx2 v[44:45], v75, s[56:57] sc1
    s_mov_b64 exec, -1
    v_lshlrev_b32_sdwa v72, 2, v34 dst_sel:DWORD dst_unused:UNUSED_PAD src0_sel:DWORD src1_sel:BYTE_3
    v_lshlrev_b32_sdwa v73, 2, v38 dst_sel:DWORD dst_unused:UNUSED_PAD src0_sel:DWORD src1_sel:BYTE_3
    v_lshlrev_b32_sdwa v74, 2, v42 dst_sel:DWORD dst_unused:UNUSED_PAD src0_sel:DWORD src1_sel:BYTE_3
    v_lshlrev_b32_sdwa v75, 2, v46 dst_sel:DWORD dst_unused:UNUSED_PAD src0_sel:DWORD src1_sel:BYTE_3
    s_mov_b64 exec, s[32:33]
    ds_add_rtn_u32 v64, v72, v117 offset:0
    s_mov_b64 exec, s[34:35]
    ds_add_rtn_u32 v65, v73, v117 offset:0
    s_mov_b64 exec, s[36:37]
    ds_add_rtn_u32 v66, v74, v117 offset:0
    s_mov_b64 exec, s[38:39]
    ds_add_rtn_u32 v67, v75, v117 offset:0
    s_cmp_eq_u64 s[48:49], 0
    s_cbranch_scc1 KB_NH
    s_mov_b64 exec, s[40:41]
    s_cbranch_execz KB_H0
    v_lshlrev_b32_sdwa v76, 2, v50 dst_sel:DWORD dst_unused:UNUSED_PAD src0_sel:DWORD src1_sel:BYTE_3
    ds_add_rtn_u32 v68, v76, v117 offset:0
    v_and_b32 v51, v118, v50
    v_lshrrev_b32 v112, 30, v50
    v_lshrrev_b32 v50, 3, v50
    v_and_b32 v50, v115, v50
    v_add_u32 v51, v51, v80
    v_mad_u32_u24 v50, v112, s0, v50
KB_H0:
    s_mov_b64 exec, s[42:43]
    s_cbranch_execz KB_H1
    v_lshlrev_b32_sdwa v77, 2, v54 dst_sel:DWORD dst_unused:UNUSED_PAD src0_sel:DWORD src1_sel:BYTE_3
    ds_add_rtn_u32 v69, v77, v117 offset:0
    v_and_b32 v55, v118, v54
    v_lshrrev_b32 v112, 30, v54
    v_lshrrev_b32 v54, 3, v54
    v_and_b32 v54, v115, v54
    v_add_u32 v55, v55, v81
    v_mad_u32_u24 v54, v112, s0, v54
KB_H1:
    s_mov_b64 exec, s[44:45]
    s_cbranch_execz KB_H2
    v_lshlrev_b32_sdwa v78, 2, v58 dst_sel:DWORD dst_unused:UNUSED_PAD src0_sel:DWORD src1_sel:BYTE_3
    ds_add_rtn_u32 v70, v78, v117 offset:0
    v_and_b32 v59, v118, v58
    v_lshrrev_b32 v112, 30, v58
    v_lshrrev_b32 v58, 3, v58
    v_and_b32 v58, v115, v58
    v_add_u32 v59, v59, v82
    v_mad_u32_u24 v58, v112, s0, v58
KB_H2:
    s_mov_b64 exec, s[46:47]
    s_cbranch_execz KB_H3
    v_lshlrev_b32_sdwa v79, 2, v62 dst_sel:DWORD dst_unused:UNUSED_PAD src0_sel:DWORD src1_sel:BYTE_3
    ds_add_rtn_u32 v71, v79, v117 offset:0
    v_and_b32 v63, v118, v62
    v_lshrrev_b32 v112, 30, v62
    v_lshrrev_b32 v62, 3, v62
    v_and_b32 v62, v115, v62
    v_add_u32 v63, v63, v83
    v_mad_u32_u24 v62, v112, s0, v62
KB_H3:
KB_NH:
    s_mov_b64 exec, -1
    v_and_b32 v35, v118, v34
    v_lshrrev_b32 v112, 30, v34
    v_lshrrev_b32 v34, 3, v34
    v_and_b32 v34, v115, v34
    v_add_u32 v35, v35, v80
    v_mad_u32_u24 v34, v112, s0, v34
    v_and_b32 v39, v118, v38
    v_lshrrev_b32 v112, 30, v38
    v_lshrrev_b32 v38, 3, v38
    v_and_b32 v38, v115, v38
    v_add_u32 v39, v39, v81
    v_mad_u32_u24 v38, v112, s0, v38
    v_and_b32 v43, v118, v42
    v_lshrrev_b32 v112, 30, v42
    v_lshrrev_b32 v42, 3, v42
    v_and_b32 v42, v115, v42
    v_add_u32 v43, v43, v82
    v_mad_u32_u24 v42, v112, s0, v42
    v_and_b32 v47, v118, v46
    v_lshrrev_b32 v112, 30, v46
    v_lshrrev_b32 v46, 3, v46
    v_and_b32 v46, v115, v46
    v_add_u32 v47, v47, v83
    v_mad_u32_u24 v46, v112, s0, v46
    s_waitcnt lgkmcnt(0)
    s_barrier
    s_cmp_eq_u32 s19, 0
    s_cbranch_scc0 KB_NOSCAN
    s_setprio 3
    ds_read_b128 v[84:87], v114 offset:0
    s_waitcnt lgkmcnt(0)
    v_add_u32 v90, v84, v85
    v_add_u32 v91, v90, v86
    v_add_u32 v88, v91, v87
    v_add_u32 v116, v91, v87
    s_nop 1
    v_add_u32_dpp v116, v116, v116 row_shr:1 row_mask:0xf bank_mask:0xf bound_ctrl:0
    s_nop 1
    v_add_u32_dpp v116, v116, v116 row_shr:2 row_mask:0xf bank_mask:0xf bound_ctrl:0
    s_nop 1
    v_add_u32_dpp v116, v116, v116 row_shr:4 row_mask:0xf bank_mask:0xf bound_ctrl:0
    s_nop 1
    v_add_u32_dpp v116, v116, v116 row_shr:8 row_mask:0xf bank_mask:0xf bound_ctrl:0
    s_nop 1
    v_add_u32_dpp v116, v116, v116 row_bcast:15 row_mask:0xa bank_mask:0xf
    s_nop 1
    v_add_u32_dpp v116, v116, v116 row_bcast:31 row_mask:0xc bank_mask:0xf
    s_nop 0
    v_readlane_b32 s22, v116, 63
    s_nop 0
    s_sub_u32 s22, 0, s22
    s_and_b32 s22, s22, 127
    v_add_u32 v116, s22, v116
    v_sub_u32 v88, v116, v88
    v_add_u32 v89, v88, v84
    v_add_u32 v90, v88, v90
    v_add_u32 v91, v88, v91
    ds_write_b128 v114, v[88:91] offset:1024
    s_mov_b32 exec_lo, 0
    s_brev_b32 exec_hi, 1
    ds_write_b32 v9, v116 offset:16
    s_mov_b64 exec, -1
    s_waitcnt lgkmcnt(0)
    s_barrier
    s_setprio 0
    v_mov_b64 v[88:89], 0
    v_mov_b32 v90, 512
    v_mov_b32 v91, 672137215
    v_lshlrev_b32 v115, 2, v113
    v_cmp_gt_u32 vcc, s22, v115
    v_lshlrev_b32 v116, 1, v115
    s_mov_b64 exec, vcc
    ds_write_b64 v116, v[88:89] offset:42240
    ds_write2st64_b32 v115, v90, v91 offset0:41 offset1:103
    s_mov_b64 exec, -1
    s_waitcnt vmcnt(0)
    s_branch KB_PLACE
KB_NOSCAN:
    v_xor_b32 v112, s3, v72
    v_cmp_gt_u32 vcc, 48, v112
    v_mul_u32_u24 v112, 32, v35
    s_and_b64 vcc, vcc, s[32:33]
    s_or_b64 exec, vcc, 1
    buffer_load_dword v127, v112, s[8:11], 0 offen
    s_mov_b64 exec, -1
    v_xor_b32 v112, s3, v73
    v_cmp_gt_u32 vcc, 48, v112
    v_mul_u32_u24 v112, 32, v39
    s_and_b64 vcc, vcc, s[34:35]
    s_or_b64 exec, vcc, 1
    buffer_load_dword v127, v112, s[8:11], 0 offen
    s_mov_b64 exec, -1
    v_xor_b32 v112, s3, v74
    v_cmp_gt_u32 vcc, 48, v112
    v_mul_u32_u24 v112, 32, v43
    s_and_b64 vcc, vcc, s[36:37]
    s_or_b64 exec, vcc, 1
    buffer_load_dword v127, v112, s[8:11], 0 offen
    s_mov_b64 exec, -1
    v_xor_b32 v112, s3, v75
    v_cmp_gt_u32 vcc, 48, v112
    v_mul_u32_u24 v112, 32, v47
    s_and_b64 vcc, vcc, s[38:39]
    s_or_b64 exec, vcc, 1
    buffer_load_dword v127, v112, s[8:11], 0 offen
    s_mov_b64 exec, -1
    s_barrier
KB_PLACE:
    ds_read2_b32 v[84:85], v9 offset0:1 offset1:4
    s_mov_b64 exec, s[32:33]
    ds_read_b32 v72, v72 offset:1024
    s_mov_b64 exec, s[34:35]
    ds_read_b32 v73, v73 offset:1024
    s_mov_b64 exec, s[36:37]
    ds_read_b32 v74, v74 offset:1024
    s_mov_b64 exec, s[38:39]
    ds_read_b32 v75, v75 offset:1024
    s_cmp_eq_u64 s[48:49], 0
    s_cbranch_scc1 KB_NR
    s_mov_b64 exec, s[40:41]
    s_cbranch_execz KB_R0
    ds_read_b32 v76, v76 offset:1024
KB_R0:
    s_mov_b64 exec, s[42:43]
    s_cbranch_execz KB_R1
    ds_read_b32 v77, v77 offset:1024
KB_R1:
    s_mov_b64 exec, s[44:45]
    s_cbranch_execz KB_R2
    ds_read_b32 v78, v78 offset:1024
KB_R2:
    s_mov_b64 exec, s[46:47]
    s_cbranch_execz KB_R3
    ds_read_b32 v79, v79 offset:1024
KB_R3:
KB_NR:
    s_mov_b64 exec, -1
    s_waitcnt lgkmcnt(0)
    v_readfirstlane_b32 s22, v85
    v_readfirstlane_b32 s28, v84
    s_nop 1
    s_cmp_le_u32 s22, 15616
    s_cbranch_scc0 KB_NARROW
    s_add_u32 s23, s22, 127
    s_lshr_b32 s23, s23, 7
    s_waitcnt vmcnt(4)
    s_mov_b64 exec, s[32:33]
    v_add_u32 v72, v72, v64
    v_add_u32 v64, v72, v72
    v_and_b32 v112, 64, v72
    ds_write_b64 v64, v[32:33] offset:42240
    v_mad_i32_i24 v34, v112, -8, v34
    ds_write2st64_b32 v72, v34, v35 offset0:41 offset1:103
    s_mov_b64 exec, s[34:35]
    v_add_u32 v73, v73, v65
    v_add_u32 v65, v73, v73
    v_and_b32 v112, 64, v73
    ds_write_b64 v65, v[36:37] offset:42240
    v_mad_i32_i24 v38, v112, -8, v38
    ds_write2st64_b32 v73, v38, v39 offset0:41 offset1:103
    s_mov_b64 exec, s[36:37]
    v_add_u32 v74, v74, v66
    v_add_u32 v66, v74, v74
    v_and_b32 v112, 64, v74
    ds_write_b64 v66, v[40:41] offset:42240
    v_mad_i32_i24 v42, v112, -8, v42
    ds_write2st64_b32 v74, v42, v43 offset0:41 offset1:103
    s_mov_b64 exec, s[38:39]
    v_add_u32 v75, v75, v67
    v_add_u32 v67, v75, v75
    v_and_b32 v112, 64, v75
    ds_write_b64 v67, v[44:45] offset:42240
    v_mad_i32_i24 v46, v112, -8, v46
    ds_write2st64_b32 v75, v46, v47 offset0:41 offset1:103
    s_cmp_eq_u64 s[48:49], 0
    s_cbranch_scc1 KB_NP
    s_mov_b64 exec, s[40:41]
    s_cbranch_execz KB_P0
    v_add_u32 v76, v76, v68
    v_add_u32 v68, v76, v76
    v_and_b32 v112, 64, v76
    ds_write_b64 v68, v[48:49] offset:42240
    v_mad_i32_i24 v50, v112, -8, v50
    ds_write2st64_b32 v76, v50, v51 offset0:41 offset1:103
KB_P0:
    s_mov_b64 exec, s[42:43]
    s_cbranch_execz KB_P1
    v_add_u32 v77, v77, v69
    v_add_u32 v69, v77, v77
    v_and_b32 v112, 64, v77
    ds_write_b64 v69, v[52:53] offset:42240
    v_mad_i32_i24 v54, v112, -8, v54
    ds_write2st64_b32 v77, v54, v55 offset0:41 offset1:103
KB_P1:
    s_mov_b64 exec, s[44:45]
    s_cbranch_execz KB_P2
    v_add_u32 v78, v78, v70
    v_add_u32 v70, v78, v78
    v_and_b32 v112, 64, v78
    ds_write_b64 v70, v[56:57] offset:42240
    v_mad_i32_i24 v58, v112, -8, v58
    ds_write2st64_b32 v78, v58, v59 offset0:41 offset1:103
KB_P2:
    s_mov_b64 exec, s[46:47]
    s_cbranch_execz KB_P3
    v_add_u32 v79, v79, v71
    v_add_u32 v71, v79, v79
    v_and_b32 v112, 64, v79
    ds_write_b64 v71, v[60:61] offset:42240
    v_mad_i32_i24 v62, v112, -8, v62
    ds_write2st64_b32 v79, v62, v63 offset0:41 offset1:103
KB_P3:
KB_NP:
    s_mov_b64 exec, -1
    s_waitcnt lgkmcnt(0)
    s_barrier
    s_cmp_ge_u32 s19, s23
    s_cbranch_scc1 KM_DONE
    ds_read_b32 v12, v12 offset:26368
    ds_read_b128 v[104:107], v13 offset:10496
    ds_read_b32 v11, v11 offset:26368
    ds_read_b64 v[124:125], v15 offset:42240
    ds_read_b128 v[108:111], v13 offset:10512
    s_waitcnt lgkmcnt(4)
    v_mad_u32_u24 v12, v12, 32, v3
    s_mov_b32 exec_lo, 0xffffff80
    s_mov_b32 exec_hi, 0xffffff80
    buffer_load_dwordx4 v[120:123], v12, s[8:11], 0 offen
    s_mov_b64 exec, -1
    s_waitcnt lgkmcnt(3)
    buffer_load_dwordx4 v[64:67], v104, s[4:7], 0 offen
    buffer_load_dwordx4 v[68:71], v105, s[4:7], 0 offen
    buffer_load_dwordx4 v[72:75], v106, s[4:7], 0 offen
    buffer_load_dwordx4 v[76:79], v107, s[4:7], 0 offen
    s_waitcnt lgkmcnt(0)
    v_xor_b32_dpp v15, v11, v11 row_shl:1 row_mask:0xf bank_mask:0xf bound_ctrl:0
    v_cmp_ne_u32_sdwa s[26:27], v15, 0 src0_sel:BYTE_3 src1_sel:DWORD
    v_readlane_b32 s32, v12, 0
    v_readlane_b32 s40, v12, 1
    v_readlane_b32 s48, v12, 2
    v_readlane_b32 s56, v12, 3
    v_readlane_b32 s64, v12, 4
    v_readlane_b32 s72, v12, 5
    v_readlane_b32 s80, v12, 6
    s_buffer_load_dwordx8 s[32:39], s[8:11], s32
    s_buffer_load_dwordx8 s[40:47], s[8:11], s40
    s_buffer_load_dwordx8 s[48:55], s[8:11], s48
    s_buffer_load_dwordx8 s[56:63], s[8:11], s56
    s_buffer_load_dwordx8 s[64:71], s[8:11], s64
    s_buffer_load_dwordx8 s[72:79], s[8:11], s72
    s_buffer_load_dwordx8 s[80:87], s[8:11], s80
    s_waitcnt lgkmcnt(0)
    s_mov_b64 exec, 0x1
    v_mov_b64 v[120:121], s[32:33]
    v_mov_b64 v[122:123], s[34:35]
    s_lshl_b64 exec, exec, 1
    v_mov_b64 v[120:121], s[40:41]
    v_mov_b64 v[122:123], s[42:43]
    s_lshl_b64 exec, exec, 1
    v_mov_b64 v[120:121], s[48:49]
    v_mov_b64 v[122:123], s[50:51]
    s_lshl_b64 exec, exec, 1
    v_mov_b64 v[120:121], s[56:57]
    v_mov_b64 v[122:123], s[58:59]
    s_lshl_b64 exec, exec, 1
    v_mov_b64 v[120:121], s[64:65]
    v_mov_b64 v[122:123], s[66:67]
    s_lshl_b64 exec, exec, 1
    v_mov_b64 v[120:121], s[72:73]
    v_mov_b64 v[122:123], s[74:75]
    s_lshl_b64 exec, exec, 1
    v_mov_b64 v[120:121], s[80:81]
    v_mov_b64 v[122:123], s[82:83]
    s_lshl_b64 exec, exec, 26
    v_mov_b64 v[120:121], s[36:37]
    v_mov_b64 v[122:123], s[38:39]
    s_lshl_b64 exec, exec, 1
    v_mov_b64 v[120:121], s[44:45]
    v_mov_b64 v[122:123], s[46:47]
    s_lshl_b64 exec, exec, 1
    v_mov_b64 v[120:121], s[52:53]
    v_mov_b64 v[122:123], s[54:55]
    s_lshl_b64 exec, exec, 1
    v_mov_b64 v[120:121], s[60:61]
    v_mov_b64 v[122:123], s[62:63]
    s_lshl_b64 exec, exec, 1
    v_mov_b64 v[120:121], s[68:69]
    v_mov_b64 v[122:123], s[70:71]
    s_lshl_b64 exec, exec, 1
    v_mov_b64 v[120:121], s[76:77]
    v_mov_b64 v[122:123], s[78:79]
    s_lshl_b64 exec, exec, 1
    v_mov_b64 v[120:121], s[84:85]
    v_mov_b64 v[122:123], s[86:87]
    s_mov_b64 exec, -1
    s_waitcnt vmcnt(4)
    s_mov_b32 s88, 0xbfb8aa3b
    s_mov_b32 s89, 0xbfb8aa3b
    s_min_u32 s22, s23, 72
.p2align 6
KM_LOOP:
    s_setprio 3
    v_mfma_f32_4x4x4_16b_bf16 v[48:51], v[124:125], v[24:25], 0
    v_add_u32_dpp v14, v10, v4 row_newbcast:15 row_mask:0xf bank_mask:0xf
    v_mfma_f32_4x4x4_16b_bf16 v[52:55], v[124:125], v[26:27], 0
    v_cvt_f64_f32 v[96:97], v88
    ds_add_f64 v14, v[96:97] offset:0
    v_mfma_f32_4x4x4_16b_bf16 v[56:59], v[124:125], v[28:29], 0
    v_cvt_f64_f32 v[98:99], v89
    ds_add_f64 v14, v[98:99] offset:272
    v_mfma_f32_4x4x4_16b_bf16 v[60:63], v[124:125], v[30:31], 0
    v_cvt_f64_f32 v[100:101], v90
    ds_add_f64 v14, v[100:101] offset:544
    s_waitcnt vmcnt(4)
    v_mfma_f32_32x32x16_bf16 v[32:47], v[120:123], v[16:19], 0
    v_cvt_pk_bf16_f32 v116, v48, v52
    v_cvt_pk_bf16_f32 v118, v49, v53
    v_cvt_f64_f32 v[102:103], v91
    ds_add_f64 v14, v[102:103] offset:816
    v_cvt_f64_f32 v[96:97], v92
    ds_add_f64 v14, v[96:97] offset:1088
    v_cvt_pk_bf16_f32 v117, v56, v60
    v_cvt_pk_bf16_f32 v119, v57, v61
    v_mfma_f32_32x32x16_bf16 v[48:63], v[120:123], v[20:23], 0
    v_cvt_f64_f32 v[98:99], v93
    ds_add_f64 v14, v[98:99] offset:1360
    v_cvt_f64_f32 v[100:101], v94
    ds_add_f64 v14, v[100:101] offset:1632
    v_cvt_f64_f32 v[102:103], v95
    ds_add_f64 v14, v[102:103] offset:1904
    v_mul_u32_u24_sdwa v10, s30, v11 dst_sel:DWORD dst_unused:UNUSED_PAD src0_sel:DWORD src1_sel:BYTE_3
    s_or_b32 s25, s26, s27
    v_exp_f32 v112, v32
    v_exp_f32 v113, v33
    s_nop 1
    v_exp_f32 v114, v48
    v_exp_f32 v115, v49
    s_nop 0
    v_pk_fma_f32 v[112:113], v[112:113], s[88:89], s[88:89]
    v_pk_fma_f32 v[114:115], v[114:115], s[88:89], s[88:89]
    s_waitcnt vmcnt(3)
    v_mfma_f32_4x4x4_16b_bf16 v[80:83], v[116:117], v[64:65], 0 cbsz:3 abid:0
    v_rcp_f32 v112, v112
    v_mfma_f32_4x4x4_16b_bf16 v[84:87], v[116:117], v[66:67], 0 cbsz:3 abid:0
    v_rcp_f32 v113, v113
    v_rcp_f32 v114, v114
    v_rcp_f32 v115, v115
    buffer_load_dwordx4 v[64:67], v108, s[4:7], 0 offen
    ds_read_b128 v[104:107], v13 offset:10528
    v_pk_mul_f32 v[32:33], v[32:33], v[112:113]
    v_pk_mul_f32 v[48:49], v[48:49], v[114:115]
    v_pk_mul_f32 v[88:89], v[32:33], v[80:81] op_sel:[0,0] op_sel_hi:[0,1]
    v_pk_mul_f32 v[90:91], v[32:33], v[82:83] op_sel:[0,0] op_sel_hi:[0,1]
    v_pk_mul_f32 v[92:93], v[48:49], v[84:85] op_sel:[0,0] op_sel_hi:[0,1]
    v_pk_mul_f32 v[94:95], v[48:49], v[86:87] op_sel:[0,0] op_sel_hi:[0,1]
    s_waitcnt vmcnt(3)
    v_mfma_f32_4x4x4_16b_bf16 v[80:83], v[116:117], v[68:69], 0 cbsz:3 abid:1
    v_exp_f32 v112, v34
    v_mfma_f32_4x4x4_16b_bf16 v[84:87], v[116:117], v[70:71], 0 cbsz:3 abid:1
    v_exp_f32 v113, v35
    v_exp_f32 v114, v50
    v_exp_f32 v115, v51
    buffer_load_dwordx4 v[68:71], v109, s[4:7], 0 offen
    s_mov_b64 exec, 1
    ds_add_rtn_u32 v15, v9, v8
    s_mov_b64 exec, -1
    v_pk_fma_f32 v[112:113], v[112:113], s[88:89], s[88:89]
    v_pk_fma_f32 v[114:115], v[114:115], s[88:89], s[88:89]
    s_bitcmp1_b32 s25, 0
    s_cbranch_scc1 KM_F1
    v_pk_fma_f32 v[88:89], v[32:33], v[80:81], v[88:89] op_sel:[1,0,0] op_sel_hi:[1,1,1]
    v_pk_fma_f32 v[90:91], v[32:33], v[82:83], v[90:91] op_sel:[1,0,0] op_sel_hi:[1,1,1]
    v_pk_fma_f32 v[92:93], v[48:49], v[84:85], v[92:93] op_sel:[1,0,0] op_sel_hi:[1,1,1]
    v_pk_fma_f32 v[94:95], v[48:49], v[86:87], v[94:95] op_sel:[1,0,0] op_sel_hi:[1,1,1]
KM_R1:
    s_waitcnt vmcnt(3)
    v_mfma_f32_4x4x4_16b_bf16 v[80:83], v[116:117], v[72:73], 0 cbsz:3 abid:2
    v_rcp_f32 v112, v112
    v_mfma_f32_4x4x4_16b_bf16 v[84:87], v[116:117], v[74:75], 0 cbsz:3 abid:2
    v_rcp_f32 v113, v113
    v_rcp_f32 v114, v114
    v_rcp_f32 v115, v115
    s_waitcnt lgkmcnt(0)
    buffer_load_dwordx4 v[72:75], v110, s[4:7], 0 offen
    v_readfirstlane_b32 s24, v15
    v_pk_mul_f32 v[34:35], v[34:35], v[112:113]
    v_pk_mul_f32 v[50:51], v[50:51], v[114:115]
    s_bitcmp1_b32 s25, 1
    s_cbranch_scc1 KM_F2
    v_pk_fma_f32 v[88:89], v[34:35], v[80:81], v[88:89] op_sel:[0,0,0] op_sel_hi:[0,1,1]
    v_pk_fma_f32 v[90:91], v[34:35], v[82:83], v[90:91] op_sel:[0,0,0] op_sel_hi:[0,1,1]
    v_pk_fma_f32 v[92:93], v[50:51], v[84:85], v[92:93] op_sel:[0,0,0] op_sel_hi:[0,1,1]
    v_pk_fma_f32 v[94:95], v[50:51], v[86:87], v[94:95] op_sel:[0,0,0] op_sel_hi:[0,1,1]
KM_R2:
KM_B0:
    s_cmp_ge_u32 s24, s22
    s_cbranch_scc1 KM_B1
    s_waitcnt vmcnt(3)
    v_mfma_f32_4x4x4_16b_bf16 v[80:83], v[116:117], v[76:77], 0 cbsz:3 abid:3
    v_exp_f32 v112, v36
    v_mfma_f32_4x4x4_16b_bf16 v[84:87], v[116:117], v[78:79], 0 cbsz:3 abid:3
    v_exp_f32 v113, v37
    v_exp_f32 v114, v52
    v_exp_f32 v115, v53
    buffer_load_dwordx4 v[76:79], v111, s[4:7], 0 offen
    s_lshl_b32 s29, s24, 7
    v_add_u32 v12, s29, v6
    v_add_u32 v11, s29, v5
    v_add_lshl_u32 v15, s29, v7, 1
    ds_read_b32 v12, v12 offset:26368
    ds_read_b32 v11, v11 offset:26368
    ds_read_b64 v[124:125], v15 offset:42240
    v_pk_fma_f32 v[112:113], v[112:113], s[88:89], s[88:89]
    v_pk_fma_f32 v[114:115], v[114:115], s[88:89], s[88:89]
    s_bitcmp1_b32 s25, 2
    s_cbranch_scc1 KM_F3
    v_pk_fma_f32 v[88:89], v[34:35], v[80:81], v[88:89] op_sel:[1,0,0] op_sel_hi:[1,1,1]
    v_pk_fma_f32 v[90:91], v[34:35], v[82:83], v[90:91] op_sel:[1,0,0] op_sel_hi:[1,1,1]
    v_pk_fma_f32 v[92:93], v[50:51], v[84:85], v[92:93] op_sel:[1,0,0] op_sel_hi:[1,1,1]
    v_pk_fma_f32 v[94:95], v[50:51], v[86:87], v[94:95] op_sel:[1,0,0] op_sel_hi:[1,1,1]
KM_R3_0:
    s_waitcnt vmcnt(3)
    v_mfma_f32_4x4x4_16b_bf16 v[80:83], v[116:117], v[64:65], 0 cbsz:3 abid:4
    v_rcp_f32 v112, v112
    v_mfma_f32_4x4x4_16b_bf16 v[84:87], v[116:117], v[66:67], 0 cbsz:3 abid:4
    v_rcp_f32 v113, v113
    v_rcp_f32 v114, v114
    v_rcp_f32 v115, v115
    s_waitcnt lgkmcnt(0)
    buffer_load_dwordx4 v[64:67], v104, s[4:7], 0 offen
    ds_read_b128 v[108:111], v13 offset:10544
    v_mad_u32_u24 v12, v12, 32, v3
    s_nop 0
    v_readlane_b32 s32, v12, 0
    v_readlane_b32 s40, v12, 1
    v_readlane_b32 s48, v12, 2
    v_readlane_b32 s56, v12, 3
    v_readlane_b32 s64, v12, 4
    v_readlane_b32 s72, v12, 5
    v_readlane_b32 s80, v12, 6
    s_buffer_load_dwordx8 s[32:39], s[8:11], s32
    s_buffer_load_dwordx8 s[40:47], s[8:11], s40
    s_buffer_load_dwordx8 s[48:55], s[8:11], s48
    s_buffer_load_dwordx8 s[56:63], s[8:11], s56
    s_buffer_load_dwordx8 s[64:71], s[8:11], s64
    s_buffer_load_dwordx8 s[72:79], s[8:11], s72
    s_buffer_load_dwordx8 s[80:87], s[8:11], s80
    v_pk_mul_f32 v[36:37], v[36:37], v[112:113]
    v_pk_mul_f32 v[52:53], v[52:53], v[114:115]
    s_bitcmp1_b32 s25, 3
    s_cbranch_scc1 KM_F4
    v_pk_fma_f32 v[88:89], v[36:37], v[80:81], v[88:89] op_sel:[0,0,0] op_sel_hi:[0,1,1]
    v_pk_fma_f32 v[90:91], v[36:37], v[82:83], v[90:91] op_sel:[0,0,0] op_sel_hi:[0,1,1]
    v_pk_fma_f32 v[92:93], v[52:53], v[84:85], v[92:93] op_sel:[0,0,0] op_sel_hi:[0,1,1]
    v_pk_fma_f32 v[94:95], v[52:53], v[86:87], v[94:95] op_sel:[0,0,0] op_sel_hi:[0,1,1]
KM_R4_0:
    s_waitcnt vmcnt(3)
    v_mfma_f32_4x4x4_16b_bf16 v[80:83], v[116:117], v[68:69], 0 cbsz:3 abid:5
    v_exp_f32 v112, v38
    v_mfma_f32_4x4x4_16b_bf16 v[84:87], v[116:117], v[70:71], 0 cbsz:3 abid:5
    v_exp_f32 v113, v39
    v_exp_f32 v114, v54
    v_exp_f32 v115, v55
    buffer_load_dwordx4 v[68:71], v105, s[4:7], 0 offen
    v_lshl_add_u32 v13, v3, 2, s29
    v_pk_fma_f32 v[112:113], v[112:113], s[88:89], s[88:89]
    v_pk_fma_f32 v[114:115], v[114:115], s[88:89], s[88:89]
    s_bitcmp1_b32 s25, 4
    s_cbranch_scc1 KM_F5
    v_pk_fma_f32 v[88:89], v[36:37], v[80:81], v[88:89] op_sel:[1,0,0] op_sel_hi:[1,1,1]
    v_pk_fma_f32 v[90:91], v[36:37], v[82:83], v[90:91] op_sel:[1,0,0] op_sel_hi:[1,1,1]
    v_pk_fma_f32 v[92:93], v[52:53], v[84:85], v[92:93] op_sel:[1,0,0] op_sel_hi:[1,1,1]
    v_pk_fma_f32 v[94:95], v[52:53], v[86:87], v[94:95] op_sel:[1,0,0] op_sel_hi:[1,1,1]
KM_R5_0:
    s_waitcnt vmcnt(3)
    v_mfma_f32_4x4x4_16b_bf16 v[80:83], v[116:117], v[72:73], 0 cbsz:3 abid:6
    v_rcp_f32 v112, v112
    v_mfma_f32_4x4x4_16b_bf16 v[84:87], v[116:117], v[74:75], 0 cbsz:3 abid:6
    v_rcp_f32 v113, v113
    v_rcp_f32 v114, v114
    v_rcp_f32 v115, v115
    buffer_load_dwordx4 v[72:75], v106, s[4:7], 0 offen
    v_pk_mul_f32 v[38:39], v[38:39], v[112:113]
    v_pk_mul_f32 v[54:55], v[54:55], v[114:115]
    s_bitcmp1_b32 s25, 5
    s_cbranch_scc1 KM_F6
    v_pk_fma_f32 v[88:89], v[38:39], v[80:81], v[88:89] op_sel:[0,0,0] op_sel_hi:[0,1,1]
    v_pk_fma_f32 v[90:91], v[38:39], v[82:83], v[90:91] op_sel:[0,0,0] op_sel_hi:[0,1,1]
    v_pk_fma_f32 v[92:93], v[54:55], v[84:85], v[92:93] op_sel:[0,0,0] op_sel_hi:[0,1,1]
    v_pk_fma_f32 v[94:95], v[54:55], v[86:87], v[94:95] op_sel:[0,0,0] op_sel_hi:[0,1,1]
KM_R6_0:
    s_setprio 0
    s_waitcnt vmcnt(3)
    v_mfma_f32_4x4x4_16b_bf16 v[80:83], v[116:117], v[76:77], 0 cbsz:3 abid:7
    v_exp_f32 v112, v40
    v_mfma_f32_4x4x4_16b_bf16 v[84:87], v[116:117], v[78:79], 0 cbsz:3 abid:7
    v_exp_f32 v113, v41
    v_exp_f32 v114, v56
    v_exp_f32 v115, v57
    buffer_load_dwordx4 v[76:79], v107, s[4:7], 0 offen
    v_pk_fma_f32 v[112:113], v[112:113], s[88:89], s[88:89]
    v_pk_fma_f32 v[114:115], v[114:115], s[88:89], s[88:89]
    s_bitcmp1_b32 s25, 6
    s_cbranch_scc1 KM_F7
    v_pk_fma_f32 v[88:89], v[38:39], v[80:81], v[88:89] op_sel:[1,0,0] op_sel_hi:[1,1,1]
    v_pk_fma_f32 v[90:91], v[38:39], v[82:83], v[90:91] op_sel:[1,0,0] op_sel_hi:[1,1,1]
    v_pk_fma_f32 v[92:93], v[54:55], v[84:85], v[92:93] op_sel:[1,0,0] op_sel_hi:[1,1,1]
    v_pk_fma_f32 v[94:95], v[54:55], v[86:87], v[94:95] op_sel:[1,0,0] op_sel_hi:[1,1,1]
KM_R7_0:
    s_waitcnt vmcnt(3)
    v_mfma_f32_4x4x4_16b_bf16 v[80:83], v[118:119], v[64:65], 0 cbsz:3 abid:0
    v_rcp_f32 v112, v112
    v_mfma_f32_4x4x4_16b_bf16 v[84:87], v[118:119], v[66:67], 0 cbsz:3 abid:0
    v_rcp_f32 v113, v113
    v_rcp_f32 v114, v114
    v_rcp_f32 v115, v115
    s_waitcnt lgkmcnt(0)
    buffer_load_dwordx4 v[64:67], v108, s[4:7], 0 offen
    ds_read_b128 v[104:107], v13 offset:10496
    s_mov_b64 exec, 0x1
    v_mov_b64 v[120:121], s[32:33]
    v_mov_b64 v[122:123], s[34:35]
    s_lshl_b64 exec, exec, 1
    v_mov_b64 v[120:121], s[40:41]
    v_mov_b64 v[122:123], s[42:43]
    s_lshl_b64 exec, exec, 1
    v_mov_b64 v[120:121], s[48:49]
    v_mov_b64 v[122:123], s[50:51]
    s_lshl_b64 exec, exec, 1
    v_mov_b64 v[120:121], s[56:57]
    v_mov_b64 v[122:123], s[58:59]
    s_lshl_b64 exec, exec, 1
    v_mov_b64 v[120:121], s[64:65]
    v_mov_b64 v[122:123], s[66:67]
    s_lshl_b64 exec, exec, 1
    v_mov_b64 v[120:121], s[72:73]
    v_mov_b64 v[122:123], s[74:75]
    s_lshl_b64 exec, exec, 1
    v_mov_b64 v[120:121], s[80:81]
    v_mov_b64 v[122:123], s[82:83]
    s_lshl_b64 exec, exec, 26
    v_mov_b64 v[120:121], s[36:37]
    v_mov_b64 v[122:123], s[38:39]
    s_lshl_b64 exec, exec, 1
    v_mov_b64 v[120:121], s[44:45]
    v_mov_b64 v[122:123], s[46:47]
    s_lshl_b64 exec, exec, 1
    v_mov_b64 v[120:121], s[52:53]
    v_mov_b64 v[122:123], s[54:55]
    s_lshl_b64 exec, exec, 1
    v_mov_b64 v[120:121], s[60:61]
    v_mov_b64 v[122:123], s[62:63]
    s_lshl_b64 exec, exec, 1
    v_mov_b64 v[120:121], s[68:69]
    v_mov_b64 v[122:123], s[70:71]
    s_lshl_b64 exec, exec, 1
    v_mov_b64 v[120:121], s[76:77]
    v_mov_b64 v[122:123], s[78:79]
    s_lshl_b64 exec, exec, 1
    v_mov_b64 v[120:121], s[84:85]
    v_mov_b64 v[122:123], s[86:87]
    s_mov_b64 exec, -1
    v_readlane_b32 s32, v12, 7
    v_readlane_b32 s40, v12, 8
    v_readlane_b32 s48, v12, 9
    v_readlane_b32 s56, v12, 10
    v_readlane_b32 s64, v12, 11
    v_readlane_b32 s72, v12, 12
    v_readlane_b32 s80, v12, 13
    s_buffer_load_dwordx8 s[32:39], s[8:11], s32
    s_buffer_load_dwordx8 s[40:47], s[8:11], s40
    s_buffer_load_dwordx8 s[48:55], s[8:11], s48
    s_buffer_load_dwordx8 s[56:63], s[8:11], s56
    s_buffer_load_dwordx8 s[64:71], s[8:11], s64
    s_buffer_load_dwordx8 s[72:79], s[8:11], s72
    s_buffer_load_dwordx8 s[80:87], s[8:11], s80
    v_pk_mul_f32 v[40:41], v[40:41], v[112:113]
    v_pk_mul_f32 v[56:57], v[56:57], v[114:115]
    s_bitcmp1_b32 s25, 7
    s_cbranch_scc1 KM_F8
    v_pk_fma_f32 v[88:89], v[40:41], v[80:81], v[88:89] op_sel:[0,0,0] op_sel_hi:[0,1,1]
    v_pk_fma_f32 v[90:91], v[40:41], v[82:83], v[90:91] op_sel:[0,0,0] op_sel_hi:[0,1,1]
    v_pk_fma_f32 v[92:93], v[56:57], v[84:85], v[92:93] op_sel:[0,0,0] op_sel_hi:[0,1,1]
    v_pk_fma_f32 v[94:95], v[56:57], v[86:87], v[94:95] op_sel:[0,0,0] op_sel_hi:[0,1,1]
KM_R8_0:
    s_waitcnt vmcnt(3)
    v_mfma_f32_4x4x4_16b_bf16 v[80:83], v[118:119], v[68:69], 0 cbsz:3 abid:1
    v_exp_f32 v112, v42
    v_mfma_f32_4x4x4_16b_bf16 v[84:87], v[118:119], v[70:71], 0 cbsz:3 abid:1
    v_exp_f32 v113, v43
    v_exp_f32 v114, v58
    v_exp_f32 v115, v59
    buffer_load_dwordx4 v[68:71], v109, s[4:7], 0 offen
    v_pk_fma_f32 v[112:113], v[112:113], s[88:89], s[88:89]
    v_pk_fma_f32 v[114:115], v[114:115], s[88:89], s[88:89]
    s_bitcmp1_b32 s25, 8
    s_cbranch_scc1 KM_F9
    v_pk_fma_f32 v[88:89], v[40:41], v[80:81], v[88:89] op_sel:[1,0,0] op_sel_hi:[1,1,1]
    v_pk_fma_f32 v[90:91], v[40:41], v[82:83], v[90:91] op_sel:[1,0,0] op_sel_hi:[1,1,1]
    v_pk_fma_f32 v[92:93], v[56:57], v[84:85], v[92:93] op_sel:[1,0,0] op_sel_hi:[1,1,1]
    v_pk_fma_f32 v[94:95], v[56:57], v[86:87], v[94:95] op_sel:[1,0,0] op_sel_hi:[1,1,1]
KM_R9_0:
    s_setprio 1
    s_waitcnt vmcnt(3)
    v_mfma_f32_4x4x4_16b_bf16 v[80:83], v[118:119], v[72:73], 0 cbsz:3 abid:2
    v_rcp_f32 v112, v112
    v_mfma_f32_4x4x4_16b_bf16 v[84:87], v[118:119], v[74:75], 0 cbsz:3 abid:2
    v_rcp_f32 v113, v113
    v_rcp_f32 v114, v114
    v_rcp_f32 v115, v115
    buffer_load_dwordx4 v[72:75], v110, s[4:7], 0 offen
    v_pk_mul_f32 v[42:43], v[42:43], v[112:113]
    v_pk_mul_f32 v[58:59], v[58:59], v[114:115]
    s_bitcmp1_b32 s25, 9
    s_cbranch_scc1 KM_F10
    v_pk_fma_f32 v[88:89], v[42:43], v[80:81], v[88:89] op_sel:[0,0,0] op_sel_hi:[0,1,1]
    v_pk_fma_f32 v[90:91], v[42:43], v[82:83], v[90:91] op_sel:[0,0,0] op_sel_hi:[0,1,1]
    v_pk_fma_f32 v[92:93], v[58:59], v[84:85], v[92:93] op_sel:[0,0,0] op_sel_hi:[0,1,1]
    v_pk_fma_f32 v[94:95], v[58:59], v[86:87], v[94:95] op_sel:[0,0,0] op_sel_hi:[0,1,1]
KM_R10_0:
    s_waitcnt vmcnt(3)
    v_mfma_f32_4x4x4_16b_bf16 v[80:83], v[118:119], v[76:77], 0 cbsz:3 abid:3
    v_exp_f32 v112, v44
    v_mfma_f32_4x4x4_16b_bf16 v[84:87], v[118:119], v[78:79], 0 cbsz:3 abid:3
    v_exp_f32 v113, v45
    v_exp_f32 v114, v60
    v_exp_f32 v115, v61
    buffer_load_dwordx4 v[76:79], v111, s[4:7], 0 offen
    s_mov_b32 exec_lo, 0xfff00000
    s_mov_b32 exec_hi, 0xfff00000
    buffer_load_dwordx4 v[120:123], v12, s[8:11], 0 offen
    s_mov_b64 exec, -1
    v_pk_fma_f32 v[112:113], v[112:113], s[88:89], s[88:89]
    v_pk_fma_f32 v[114:115], v[114:115], s[88:89], s[88:89]
    s_bitcmp1_b32 s25, 10
    s_cbranch_scc1 KM_F11
    v_pk_fma_f32 v[88:89], v[42:43], v[80:81], v[88:89] op_sel:[1,0,0] op_sel_hi:[1,1,1]
    v_pk_fma_f32 v[90:91], v[42:43], v[82:83], v[90:91] op_sel:[1,0,0] op_sel_hi:[1,1,1]
    v_pk_fma_f32 v[92:93], v[58:59], v[84:85], v[92:93] op_sel:[1,0,0] op_sel_hi:[1,1,1]
    v_pk_fma_f32 v[94:95], v[58:59], v[86:87], v[94:95] op_sel:[1,0,0] op_sel_hi:[1,1,1]
KM_R11_0:
    s_waitcnt vmcnt(4)
    v_mfma_f32_4x4x4_16b_bf16 v[80:83], v[118:119], v[64:65], 0 cbsz:3 abid:4
    v_rcp_f32 v112, v112
    v_mfma_f32_4x4x4_16b_bf16 v[84:87], v[118:119], v[66:67], 0 cbsz:3 abid:4
    v_rcp_f32 v113, v113
    v_rcp_f32 v114, v114
    v_rcp_f32 v115, v115
    s_waitcnt lgkmcnt(0)
    buffer_load_dwordx4 v[64:67], v104, s[4:7], 0 offen
    ds_read_b128 v[108:111], v13 offset:10512
    s_mov_b64 exec, 0x80
    v_mov_b64 v[120:121], s[32:33]
    v_mov_b64 v[122:123], s[34:35]
    s_lshl_b64 exec, exec, 1
    v_mov_b64 v[120:121], s[40:41]
    v_mov_b64 v[122:123], s[42:43]
    s_lshl_b64 exec, exec, 1
    v_mov_b64 v[120:121], s[48:49]
    v_mov_b64 v[122:123], s[50:51]
    s_lshl_b64 exec, exec, 1
    v_mov_b64 v[120:121], s[56:57]
    v_mov_b64 v[122:123], s[58:59]
    s_lshl_b64 exec, exec, 1
    v_mov_b64 v[120:121], s[64:65]
    v_mov_b64 v[122:123], s[66:67]
    s_lshl_b64 exec, exec, 1
    v_mov_b64 v[120:121], s[72:73]
    v_mov_b64 v[122:123], s[74:75]
    s_lshl_b64 exec, exec, 1
    v_mov_b64 v[120:121], s[80:81]
    v_mov_b64 v[122:123], s[82:83]
    s_lshl_b64 exec, exec, 26
    v_mov_b64 v[120:121], s[36:37]
    v_mov_b64 v[122:123], s[38:39]
    s_lshl_b64 exec, exec, 1
    v_mov_b64 v[120:121], s[44:45]
    v_mov_b64 v[122:123], s[46:47]
    s_lshl_b64 exec, exec, 1
    v_mov_b64 v[120:121], s[52:53]
    v_mov_b64 v[122:123], s[54:55]
    s_lshl_b64 exec, exec, 1
    v_mov_b64 v[120:121], s[60:61]
    v_mov_b64 v[122:123], s[62:63]
    s_lshl_b64 exec, exec, 1
    v_mov_b64 v[120:121], s[68:69]
    v_mov_b64 v[122:123], s[70:71]
    s_lshl_b64 exec, exec, 1
    v_mov_b64 v[120:121], s[76:77]
    v_mov_b64 v[122:123], s[78:79]
    s_lshl_b64 exec, exec, 1
    v_mov_b64 v[120:121], s[84:85]
    v_mov_b64 v[122:123], s[86:87]
    s_mov_b64 exec, -1
    v_readlane_b32 s32, v12, 14
    v_readlane_b32 s40, v12, 15
    v_readlane_b32 s48, v12, 16
    v_readlane_b32 s56, v12, 17
    v_readlane_b32 s64, v12, 18
    v_readlane_b32 s72, v12, 19
    s_buffer_load_dwordx8 s[32:39], s[8:11], s32
    s_buffer_load_dwordx8 s[40:47], s[8:11], s40
    s_buffer_load_dwordx8 s[48:55], s[8:11], s48
    s_buffer_load_dwordx8 s[56:63], s[8:11], s56
    s_buffer_load_dwordx8 s[64:71], s[8:11], s64
    s_buffer_load_dwordx8 s[72:79], s[8:11], s72
    v_pk_mul_f32 v[44:45], v[44:45], v[112:113]
    v_pk_mul_f32 v[60:61], v[60:61], v[114:115]
    s_bitcmp1_b32 s25, 11
    s_cbranch_scc1 KM_F12
    v_pk_fma_f32 v[88:89], v[44:45], v[80:81], v[88:89] op_sel:[0,0,0] op_sel_hi:[0,1,1]
    v_pk_fma_f32 v[90:91], v[44:45], v[82:83], v[90:91] op_sel:[0,0,0] op_sel_hi:[0,1,1]
    v_pk_fma_f32 v[92:93], v[60:61], v[84:85], v[92:93] op_sel:[0,0,0] op_sel_hi:[0,1,1]
    v_pk_fma_f32 v[94:95], v[60:61], v[86:87], v[94:95] op_sel:[0,0,0] op_sel_hi:[0,1,1]
KM_R12_0:
    s_setprio 2
    s_waitcnt vmcnt(4)
    v_mfma_f32_4x4x4_16b_bf16 v[80:83], v[118:119], v[68:69], 0 cbsz:3 abid:5
    v_exp_f32 v112, v46
    v_mfma_f32_4x4x4_16b_bf16 v[84:87], v[118:119], v[70:71], 0 cbsz:3 abid:5
    v_exp_f32 v113, v47
    v_exp_f32 v114, v62
    v_exp_f32 v115, v63
    buffer_load_dwordx4 v[68:71], v105, s[4:7], 0 offen
    v_pk_fma_f32 v[112:113], v[112:113], s[88:89], s[88:89]
    v_pk_fma_f32 v[114:115], v[114:115], s[88:89], s[88:89]
    s_bitcmp1_b32 s25, 12
    s_cbranch_scc1 KM_F13
    v_pk_fma_f32 v[88:89], v[44:45], v[80:81], v[88:89] op_sel:[1,0,0] op_sel_hi:[1,1,1]
    v_pk_fma_f32 v[90:91], v[44:45], v[82:83], v[90:91] op_sel:[1,0,0] op_sel_hi:[1,1,1]
    v_pk_fma_f32 v[92:93], v[60:61], v[84:85], v[92:93] op_sel:[1,0,0] op_sel_hi:[1,1,1]
    v_pk_fma_f32 v[94:95], v[60:61], v[86:87], v[94:95] op_sel:[1,0,0] op_sel_hi:[1,1,1]
KM_R13_0:
    s_waitcnt vmcnt(4)
    v_mfma_f32_4x4x4_16b_bf16 v[80:83], v[118:119], v[72:73], 0 cbsz:3 abid:6
    v_rcp_f32 v112, v112
    v_mfma_f32_4x4x4_16b_bf16 v[84:87], v[118:119], v[74:75], 0 cbsz:3 abid:6
    v_rcp_f32 v113, v113
    v_rcp_f32 v114, v114
    v_rcp_f32 v115, v115
    buffer_load_dwordx4 v[72:75], v106, s[4:7], 0 offen
    v_pk_mul_f32 v[46:47], v[46:47], v[112:113]
    v_pk_mul_f32 v[62:63], v[62:63], v[114:115]
    s_bitcmp1_b32 s25, 13
    s_cbranch_scc1 KM_F14
    v_pk_fma_f32 v[88:89], v[46:47], v[80:81], v[88:89] op_sel:[0,0,0] op_sel_hi:[0,1,1]
    v_pk_fma_f32 v[90:91], v[46:47], v[82:83], v[90:91] op_sel:[0,0,0] op_sel_hi:[0,1,1]
    v_pk_fma_f32 v[92:93], v[62:63], v[84:85], v[92:93] op_sel:[0,0,0] op_sel_hi:[0,1,1]
    v_pk_fma_f32 v[94:95], v[62:63], v[86:87], v[94:95] op_sel:[0,0,0] op_sel_hi:[0,1,1]
KM_R14_0:
    s_waitcnt vmcnt(4)
    v_mfma_f32_4x4x4_16b_bf16 v[80:83], v[118:119], v[76:77], 0 cbsz:3 abid:7
    v_xor_b32_dpp v15, v11, v11 row_shl:1 row_mask:0xf bank_mask:0xf bound_ctrl:0
    v_mfma_f32_4x4x4_16b_bf16 v[84:87], v[118:119], v[78:79], 0 cbsz:3 abid:7
    buffer_load_dwordx4 v[76:79], v107, s[4:7], 0 offen
    v_cmp_ne_u32_sdwa s[26:27], v15, 0 src0_sel:BYTE_3 src1_sel:DWORD
    s_bitcmp1_b32 s25, 14
    s_cbranch_scc1 KM_F15
    v_pk_fma_f32 v[88:89], v[46:47], v[80:81], v[88:89] op_sel:[1,0,0] op_sel_hi:[1,1,1]
    v_pk_fma_f32 v[90:91], v[46:47], v[82:83], v[90:91] op_sel:[1,0,0] op_sel_hi:[1,1,1]
    v_pk_fma_f32 v[92:93], v[62:63], v[84:85], v[92:93] op_sel:[1,0,0] op_sel_hi:[1,1,1]
    v_pk_fma_f32 v[94:95], v[62:63], v[86:87], v[94:95] op_sel:[1,0,0] op_sel_hi:[1,1,1]
KM_R15_0:
    s_waitcnt lgkmcnt(0)
    s_mov_b64 exec, 0x4000
    v_mov_b64 v[120:121], s[32:33]
    v_mov_b64 v[122:123], s[34:35]
    s_lshl_b64 exec, exec, 1
    v_mov_b64 v[120:121], s[40:41]
    v_mov_b64 v[122:123], s[42:43]
    s_lshl_b64 exec, exec, 1
    v_mov_b64 v[120:121], s[48:49]
    v_mov_b64 v[122:123], s[50:51]
    s_lshl_b64 exec, exec, 1
    v_mov_b64 v[120:121], s[56:57]
    v_mov_b64 v[122:123], s[58:59]
    s_lshl_b64 exec, exec, 1
    v_mov_b64 v[120:121], s[64:65]
    v_mov_b64 v[122:123], s[66:67]
    s_lshl_b64 exec, exec, 1
    v_mov_b64 v[120:121], s[72:73]
    v_mov_b64 v[122:123], s[74:75]
    s_lshl_b64 exec, exec, 27
    v_mov_b64 v[120:121], s[36:37]
    v_mov_b64 v[122:123], s[38:39]
    s_lshl_b64 exec, exec, 1
    v_mov_b64 v[120:121], s[44:45]
    v_mov_b64 v[122:123], s[46:47]
    s_lshl_b64 exec, exec, 1
    v_mov_b64 v[120:121], s[52:53]
    v_mov_b64 v[122:123], s[54:55]
    s_lshl_b64 exec, exec, 1
    v_mov_b64 v[120:121], s[60:61]
    v_mov_b64 v[122:123], s[62:63]
    s_lshl_b64 exec, exec, 1
    v_mov_b64 v[120:121], s[68:69]
    v_mov_b64 v[122:123], s[70:71]
    s_lshl_b64 exec, exec, 1
    v_mov_b64 v[120:121], s[76:77]
    v_mov_b64 v[122:123], s[78:79]
    s_mov_b64 exec, -1
    s_branch KM_LOOP
KM_B1:
    s_cmp_ge_u32 s24, s23
    s_cbranch_scc1 KM_BL
    s_waitcnt vmcnt(3)
    v_mfma_f32_4x4x4_16b_bf16 v[80:83], v[116:117], v[76:77], 0 cbsz:3 abid:3
    v_exp_f32 v112, v36
    v_mfma_f32_4x4x4_16b_bf16 v[84:87], v[116:117], v[78:79], 0 cbsz:3 abid:3
    v_exp_f32 v113, v37
    v_exp_f32 v114, v52
    v_exp_f32 v115, v53
    buffer_load_dwordx4 v[76:79], v111, s[4:7], 0 offen
    s_lshl_b32 s29, s24, 7
    v_add_u32 v12, s29, v6
    v_add_u32 v11, s29, v5
    v_add_lshl_u32 v15, s29, v7, 1
    ds_read_b32 v12, v12 offset:26368
    ds_read_b32 v11, v11 offset:26368
    ds_read_b64 v[124:125], v15 offset:42240
    v_pk_fma_f32 v[112:113], v[112:113], s[88:89], s[88:89]
    v_pk_fma_f32 v[114:115], v[114:115], s[88:89], s[88:89]
    s_bitcmp1_b32 s25, 2
    s_cbranch_scc1 KM_F3
    v_pk_fma_f32 v[88:89], v[34:35], v[80:81], v[88:89] op_sel:[1,0,0] op_sel_hi:[1,1,1]
    v_pk_fma_f32 v[90:91], v[34:35], v[82:83], v[90:91] op_sel:[1,0,0] op_sel_hi:[1,1,1]
    v_pk_fma_f32 v[92:93], v[50:51], v[84:85], v[92:93] op_sel:[1,0,0] op_sel_hi:[1,1,1]
    v_pk_fma_f32 v[94:95], v[50:51], v[86:87], v[94:95] op_sel:[1,0,0] op_sel_hi:[1,1,1]
KM_R3_1:
    s_waitcnt vmcnt(3)
    v_mfma_f32_4x4x4_16b_bf16 v[80:83], v[116:117], v[64:65], 0 cbsz:3 abid:4
    v_rcp_f32 v112, v112
    v_mfma_f32_4x4x4_16b_bf16 v[84:87], v[116:117], v[66:67], 0 cbsz:3 abid:4
    v_rcp_f32 v113, v113
    v_rcp_f32 v114, v114
    v_rcp_f32 v115, v115
    s_waitcnt lgkmcnt(0)
    buffer_load_dwordx4 v[64:67], v104, s[4:7], 0 offen
    ds_read_b128 v[108:111], v13 offset:10544
    v_mad_u32_u24 v12, v12, 32, v3
    s_nop 0
    v_readlane_b32 s32, v12, 0
    v_readlane_b32 s40, v12, 1
    v_readlane_b32 s48, v12, 2
    v_readlane_b32 s56, v12, 3
    v_readlane_b32 s64, v12, 4
    s_buffer_load_dwordx8 s[32:39], s[8:11], s32
    s_buffer_load_dwordx8 s[40:47], s[8:11], s40
    s_buffer_load_dwordx8 s[48:55], s[8:11], s48
    s_buffer_load_dwordx8 s[56:63], s[8:11], s56
    s_buffer_load_dwordx8 s[64:71], s[8:11], s64
    v_pk_mul_f32 v[36:37], v[36:37], v[112:113]
    v_pk_mul_f32 v[52:53], v[52:53], v[114:115]
    s_bitcmp1_b32 s25, 3
    s_cbranch_scc1 KM_F4
    v_pk_fma_f32 v[88:89], v[36:37], v[80:81], v[88:89] op_sel:[0,0,0] op_sel_hi:[0,1,1]
    v_pk_fma_f32 v[90:91], v[36:37], v[82:83], v[90:91] op_sel:[0,0,0] op_sel_hi:[0,1,1]
    v_pk_fma_f32 v[92:93], v[52:53], v[84:85], v[92:93] op_sel:[0,0,0] op_sel_hi:[0,1,1]
    v_pk_fma_f32 v[94:95], v[52:53], v[86:87], v[94:95] op_sel:[0,0,0] op_sel_hi:[0,1,1]
KM_R4_1:
    s_waitcnt vmcnt(3)
    v_mfma_f32_4x4x4_16b_bf16 v[80:83], v[116:117], v[68:69], 0 cbsz:3 abid:5
    v_exp_f32 v112, v38
    v_mfma_f32_4x4x4_16b_bf16 v[84:87], v[116:117], v[70:71], 0 cbsz:3 abid:5
    v_exp_f32 v113, v39
    v_exp_f32 v114, v54
    v_exp_f32 v115, v55
    buffer_load_dwordx4 v[68:71], v105, s[4:7], 0 offen
    v_lshl_add_u32 v13, v3, 2, s29
    v_pk_fma_f32 v[112:113], v[112:113], s[88:89], s[88:89]
    v_pk_fma_f32 v[114:115], v[114:115], s[88:89], s[88:89]
    s_bitcmp1_b32 s25, 4
    s_cbranch_scc1 KM_F5
    v_pk_fma_f32 v[88:89], v[36:37], v[80:81], v[88:89] op_sel:[1,0,0] op_sel_hi:[1,1,1]
    v_pk_fma_f32 v[90:91], v[36:37], v[82:83], v[90:91] op_sel:[1,0,0] op_sel_hi:[1,1,1]
    v_pk_fma_f32 v[92:93], v[52:53], v[84:85], v[92:93] op_sel:[1,0,0] op_sel_hi:[1,1,1]
    v_pk_fma_f32 v[94:95], v[52:53], v[86:87], v[94:95] op_sel:[1,0,0] op_sel_hi:[1,1,1]
KM_R5_1:
    s_waitcnt vmcnt(3)
    v_mfma_f32_4x4x4_16b_bf16 v[80:83], v[116:117], v[72:73], 0 cbsz:3 abid:6
    v_rcp_f32 v112, v112
    v_mfma_f32_4x4x4_16b_bf16 v[84:87], v[116:117], v[74:75], 0 cbsz:3 abid:6
    v_rcp_f32 v113, v113
    v_rcp_f32 v114, v114
    v_rcp_f32 v115, v115
    buffer_load_dwordx4 v[72:75], v106, s[4:7], 0 offen
    v_pk_mul_f32 v[38:39], v[38:39], v[112:113]
    v_pk_mul_f32 v[54:55], v[54:55], v[114:115]
    s_bitcmp1_b32 s25, 5
    s_cbranch_scc1 KM_F6
    v_pk_fma_f32 v[88:89], v[38:39], v[80:81], v[88:89] op_sel:[0,0,0] op_sel_hi:[0,1,1]
    v_pk_fma_f32 v[90:91], v[38:39], v[82:83], v[90:91] op_sel:[0,0,0] op_sel_hi:[0,1,1]
    v_pk_fma_f32 v[92:93], v[54:55], v[84:85], v[92:93] op_sel:[0,0,0] op_sel_hi:[0,1,1]
    v_pk_fma_f32 v[94:95], v[54:55], v[86:87], v[94:95] op_sel:[0,0,0] op_sel_hi:[0,1,1]
KM_R6_1:
    s_setprio 0
    s_waitcnt vmcnt(3)
    v_mfma_f32_4x4x4_16b_bf16 v[80:83], v[116:117], v[76:77], 0 cbsz:3 abid:7
    v_exp_f32 v112, v40
    v_mfma_f32_4x4x4_16b_bf16 v[84:87], v[116:117], v[78:79], 0 cbsz:3 abid:7
    v_exp_f32 v113, v41
    v_exp_f32 v114, v56
    v_exp_f32 v115, v57
    buffer_load_dwordx4 v[76:79], v107, s[4:7], 0 offen
    v_pk_fma_f32 v[112:113], v[112:113], s[88:89], s[88:89]
    v_pk_fma_f32 v[114:115], v[114:115], s[88:89], s[88:89]
    s_bitcmp1_b32 s25, 6
    s_cbranch_scc1 KM_F7
    v_pk_fma_f32 v[88:89], v[38:39], v[80:81], v[88:89] op_sel:[1,0,0] op_sel_hi:[1,1,1]
    v_pk_fma_f32 v[90:91], v[38:39], v[82:83], v[90:91] op_sel:[1,0,0] op_sel_hi:[1,1,1]
    v_pk_fma_f32 v[92:93], v[54:55], v[84:85], v[92:93] op_sel:[1,0,0] op_sel_hi:[1,1,1]
    v_pk_fma_f32 v[94:95], v[54:55], v[86:87], v[94:95] op_sel:[1,0,0] op_sel_hi:[1,1,1]
KM_R7_1:
    s_waitcnt vmcnt(3)
    v_mfma_f32_4x4x4_16b_bf16 v[80:83], v[118:119], v[64:65], 0 cbsz:3 abid:0
    v_rcp_f32 v112, v112
    v_mfma_f32_4x4x4_16b_bf16 v[84:87], v[118:119], v[66:67], 0 cbsz:3 abid:0
    v_rcp_f32 v113, v113
    v_rcp_f32 v114, v114
    v_rcp_f32 v115, v115
    s_waitcnt lgkmcnt(0)
    buffer_load_dwordx4 v[64:67], v108, s[4:7], 0 offen
    ds_read_b128 v[104:107], v13 offset:10496
    s_mov_b64 exec, 0x1
    v_mov_b64 v[120:121], s[32:33]
    v_mov_b64 v[122:123], s[34:35]
    s_lshl_b64 exec, exec, 1
    v_mov_b64 v[120:121], s[40:41]
    v_mov_b64 v[122:123], s[42:43]
    s_lshl_b64 exec, exec, 1
    v_mov_b64 v[120:121], s[48:49]
    v_mov_b64 v[122:123], s[50:51]
    s_lshl_b64 exec, exec, 1
    v_mov_b64 v[120:121], s[56:57]
    v_mov_b64 v[122:123], s[58:59]
    s_lshl_b64 exec, exec, 1
    v_mov_b64 v[120:121], s[64:65]
    v_mov_b64 v[122:123], s[66:67]
    s_lshl_b64 exec, exec, 28
    v_mov_b64 v[120:121], s[36:37]
    v_mov_b64 v[122:123], s[38:39]
    s_lshl_b64 exec, exec, 1
    v_mov_b64 v[120:121], s[44:45]
    v_mov_b64 v[122:123], s[46:47]
    s_lshl_b64 exec, exec, 1
    v_mov_b64 v[120:121], s[52:53]
    v_mov_b64 v[122:123], s[54:55]
    s_lshl_b64 exec, exec, 1
    v_mov_b64 v[120:121], s[60:61]
    v_mov_b64 v[122:123], s[62:63]
    s_lshl_b64 exec, exec, 1
    v_mov_b64 v[120:121], s[68:69]
    v_mov_b64 v[122:123], s[70:71]
    s_mov_b64 exec, -1
    v_pk_mul_f32 v[40:41], v[40:41], v[112:113]
    v_pk_mul_f32 v[56:57], v[56:57], v[114:115]
    s_bitcmp1_b32 s25, 7
    s_cbranch_scc1 KM_F8
    v_pk_fma_f32 v[88:89], v[40:41], v[80:81], v[88:89] op_sel:[0,0,0] op_sel_hi:[0,1,1]
    v_pk_fma_f32 v[90:91], v[40:41], v[82:83], v[90:91] op_sel:[0,0,0] op_sel_hi:[0,1,1]
    v_pk_fma_f32 v[92:93], v[56:57], v[84:85], v[92:93] op_sel:[0,0,0] op_sel_hi:[0,1,1]
    v_pk_fma_f32 v[94:95], v[56:57], v[86:87], v[94:95] op_sel:[0,0,0] op_sel_hi:[0,1,1]
KM_R8_1:
    s_waitcnt vmcnt(3)
    v_mfma_f32_4x4x4_16b_bf16 v[80:83], v[118:119], v[68:69], 0 cbsz:3 abid:1
    v_exp_f32 v112, v42
    v_mfma_f32_4x4x4_16b_bf16 v[84:87], v[118:119], v[70:71], 0 cbsz:3 abid:1
    v_exp_f32 v113, v43
    v_exp_f32 v114, v58
    v_exp_f32 v115, v59
    buffer_load_dwordx4 v[68:71], v109, s[4:7], 0 offen
    v_pk_fma_f32 v[112:113], v[112:113], s[88:89], s[88:89]
    v_pk_fma_f32 v[114:115], v[114:115], s[88:89], s[88:89]
    s_bitcmp1_b32 s25, 8
    s_cbranch_scc1 KM_F9
    v_pk_fma_f32 v[88:89], v[40:41], v[80:81], v[88:89] op_sel:[1,0,0] op_sel_hi:[1,1,1]
    v_pk_fma_f32 v[90:91], v[40:41], v[82:83], v[90:91] op_sel:[1,0,0] op_sel_hi:[1,1,1]
    v_pk_fma_f32 v[92:93], v[56:57], v[84:85], v[92:93] op_sel:[1,0,0] op_sel_hi:[1,1,1]
    v_pk_fma_f32 v[94:95], v[56:57], v[86:87], v[94:95] op_sel:[1,0,0] op_sel_hi:[1,1,1]
KM_R9_1:
    s_setprio 1
    s_waitcnt vmcnt(3)
    v_mfma_f32_4x4x4_16b_bf16 v[80:83], v[118:119], v[72:73], 0 cbsz:3 abid:2
    v_rcp_f32 v112, v112
    v_mfma_f32_4x4x4_16b_bf16 v[84:87], v[118:119], v[74:75], 0 cbsz:3 abid:2
    v_rcp_f32 v113, v113
    v_rcp_f32 v114, v114
    v_rcp_f32 v115, v115
    buffer_load_dwordx4 v[72:75], v110, s[4:7], 0 offen
    v_pk_mul_f32 v[42:43], v[42:43], v[112:113]
    v_pk_mul_f32 v[58:59], v[58:59], v[114:115]
    s_bitcmp1_b32 s25, 9
    s_cbranch_scc1 KM_F10
    v_pk_fma_f32 v[88:89], v[42:43], v[80:81], v[88:89] op_sel:[0,0,0] op_sel_hi:[0,1,1]
    v_pk_fma_f32 v[90:91], v[42:43], v[82:83], v[90:91] op_sel:[0,0,0] op_sel_hi:[0,1,1]
    v_pk_fma_f32 v[92:93], v[58:59], v[84:85], v[92:93] op_sel:[0,0,0] op_sel_hi:[0,1,1]
    v_pk_fma_f32 v[94:95], v[58:59], v[86:87], v[94:95] op_sel:[0,0,0] op_sel_hi:[0,1,1]
KM_R10_1:
    s_waitcnt vmcnt(3)
    v_mfma_f32_4x4x4_16b_bf16 v[80:83], v[118:119], v[76:77], 0 cbsz:3 abid:3
    v_exp_f32 v112, v44
    v_mfma_f32_4x4x4_16b_bf16 v[84:87], v[118:119], v[78:79], 0 cbsz:3 abid:3
    v_exp_f32 v113, v45
    v_exp_f32 v114, v60
    v_exp_f32 v115, v61
    buffer_load_dwordx4 v[76:79], v111, s[4:7], 0 offen
    s_mov_b32 exec_lo, 0xffffffe0
    s_mov_b32 exec_hi, 0xffffffe0
    buffer_load_dwordx4 v[120:123], v12, s[8:11], 0 offen
    s_mov_b64 exec, -1
    v_pk_fma_f32 v[112:113], v[112:113], s[88:89], s[88:89]
    v_pk_fma_f32 v[114:115], v[114:115], s[88:89], s[88:89]
    s_bitcmp1_b32 s25, 10
    s_cbranch_scc1 KM_F11
    v_pk_fma_f32 v[88:89], v[42:43], v[80:81], v[88:89] op_sel:[1,0,0] op_sel_hi:[1,1,1]
    v_pk_fma_f32 v[90:91], v[42:43], v[82:83], v[90:91] op_sel:[1,0,0] op_sel_hi:[1,1,1]
    v_pk_fma_f32 v[92:93], v[58:59], v[84:85], v[92:93] op_sel:[1,0,0] op_sel_hi:[1,1,1]
    v_pk_fma_f32 v[94:95], v[58:59], v[86:87], v[94:95] op_sel:[1,0,0] op_sel_hi:[1,1,1]
KM_R11_1:
    s_waitcnt vmcnt(4)
    v_mfma_f32_4x4x4_16b_bf16 v[80:83], v[118:119], v[64:65], 0 cbsz:3 abid:4
    v_rcp_f32 v112, v112
    v_mfma_f32_4x4x4_16b_bf16 v[84:87], v[118:119], v[66:67], 0 cbsz:3 abid:4
    v_rcp_f32 v113, v113
    v_rcp_f32 v114, v114
    v_rcp_f32 v115, v115
    s_waitcnt lgkmcnt(0)
    buffer_load_dwordx4 v[64:67], v104, s[4:7], 0 offen
    ds_read_b128 v[108:111], v13 offset:10512
    v_pk_mul_f32 v[44:45], v[44:45], v[112:113]
    v_pk_mul_f32 v[60:61], v[60:61], v[114:115]
    s_bitcmp1_b32 s25, 11
    s_cbranch_scc1 KM_F12
    v_pk_fma_f32 v[88:89], v[44:45], v[80:81], v[88:89] op_sel:[0,0,0] op_sel_hi:[0,1,1]
    v_pk_fma_f32 v[90:91], v[44:45], v[82:83], v[90:91] op_sel:[0,0,0] op_sel_hi:[0,1,1]
    v_pk_fma_f32 v[92:93], v[60:61], v[84:85], v[92:93] op_sel:[0,0,0] op_sel_hi:[0,1,1]
    v_pk_fma_f32 v[94:95], v[60:61], v[86:87], v[94:95] op_sel:[0,0,0] op_sel_hi:[0,1,1]
KM_R12_1:
    s_setprio 2
    s_waitcnt vmcnt(4)
    v_mfma_f32_4x4x4_16b_bf16 v[80:83], v[118:119], v[68:69], 0 cbsz:3 abid:5
    v_exp_f32 v112, v46
    v_mfma_f32_4x4x4_16b_bf16 v[84:87], v[118:119], v[70:71], 0 cbsz:3 abid:5
    v_exp_f32 v113, v47
    v_exp_f32 v114, v62
    v_exp_f32 v115, v63
    buffer_load_dwordx4 v[68:71], v105, s[4:7], 0 offen
    v_pk_fma_f32 v[112:113], v[112:113], s[88:89], s[88:89]
    v_pk_fma_f32 v[114:115], v[114:115], s[88:89], s[88:89]
    s_bitcmp1_b32 s25, 12
    s_cbranch_scc1 KM_F13
    v_pk_fma_f32 v[88:89], v[44:45], v[80:81], v[88:89] op_sel:[1,0,0] op_sel_hi:[1,1,1]
    v_pk_fma_f32 v[90:91], v[44:45], v[82:83], v[90:91] op_sel:[1,0,0] op_sel_hi:[1,1,1]
    v_pk_fma_f32 v[92:93], v[60:61], v[84:85], v[92:93] op_sel:[1,0,0] op_sel_hi:[1,1,1]
    v_pk_fma_f32 v[94:95], v[60:61], v[86:87], v[94:95] op_sel:[1,0,0] op_sel_hi:[1,1,1]
KM_R13_1:
    s_waitcnt vmcnt(4)
    v_mfma_f32_4x4x4_16b_bf16 v[80:83], v[118:119], v[72:73], 0 cbsz:3 abid:6
    v_rcp_f32 v112, v112
    v_mfma_f32_4x4x4_16b_bf16 v[84:87], v[118:119], v[74:75], 0 cbsz:3 abid:6
    v_rcp_f32 v113, v113
    v_rcp_f32 v114, v114
    v_rcp_f32 v115, v115
    buffer_load_dwordx4 v[72:75], v106, s[4:7], 0 offen
    s_waitcnt lgkmcnt(0)
    v_pk_mul_f32 v[46:47], v[46:47], v[112:113]
    v_pk_mul_f32 v[62:63], v[62:63], v[114:115]
    s_bitcmp1_b32 s25, 13
    s_cbranch_scc1 KM_F14
    v_pk_fma_f32 v[88:89], v[46:47], v[80:81], v[88:89] op_sel:[0,0,0] op_sel_hi:[0,1,1]
    v_pk_fma_f32 v[90:91], v[46:47], v[82:83], v[90:91] op_sel:[0,0,0] op_sel_hi:[0,1,1]
    v_pk_fma_f32 v[92:93], v[62:63], v[84:85], v[92:93] op_sel:[0,0,0] op_sel_hi:[0,1,1]
    v_pk_fma_f32 v[94:95], v[62:63], v[86:87], v[94:95] op_sel:[0,0,0] op_sel_hi:[0,1,1]
KM_R14_1:
    s_waitcnt vmcnt(4)
    v_mfma_f32_4x4x4_16b_bf16 v[80:83], v[118:119], v[76:77], 0 cbsz:3 abid:7
    v_xor_b32_dpp v15, v11, v11 row_shl:1 row_mask:0xf bank_mask:0xf bound_ctrl:0
    v_mfma_f32_4x4x4_16b_bf16 v[84:87], v[118:119], v[78:79], 0 cbsz:3 abid:7
    buffer_load_dwordx4 v[76:79], v107, s[4:7], 0 offen
    v_cmp_ne_u32_sdwa s[26:27], v15, 0 src0_sel:BYTE_3 src1_sel:DWORD
    s_bitcmp1_b32 s25, 14
    s_cbranch_scc1 KM_F15
    v_pk_fma_f32 v[88:89], v[46:47], v[80:81], v[88:89] op_sel:[1,0,0] op_sel_hi:[1,1,1]
    v_pk_fma_f32 v[90:91], v[46:47], v[82:83], v[90:91] op_sel:[1,0,0] op_sel_hi:[1,1,1]
    v_pk_fma_f32 v[92:93], v[62:63], v[84:85], v[92:93] op_sel:[1,0,0] op_sel_hi:[1,1,1]
    v_pk_fma_f32 v[94:95], v[62:63], v[86:87], v[94:95] op_sel:[1,0,0] op_sel_hi:[1,1,1]
KM_R15_1:
    s_branch KM_LOOP
KM_BL:
    s_setprio 1
    s_waitcnt vmcnt(3)
    v_mfma_f32_4x4x4_16b_bf16 v[80:83], v[116:117], v[76:77], 0 cbsz:3 abid:3
    v_exp_f32 v112, v36
    v_mfma_f32_4x4x4_16b_bf16 v[84:87], v[116:117], v[78:79], 0 cbsz:3 abid:3
    v_exp_f32 v113, v37
    v_exp_f32 v114, v52
    v_exp_f32 v115, v53
    buffer_load_dwordx4 v[76:79], v111, s[4:7], 0 offen
    v_pk_fma_f32 v[112:113], v[112:113], s[88:89], s[88:89]
    v_pk_fma_f32 v[114:115], v[114:115], s[88:89], s[88:89]
    s_bitcmp1_b32 s25, 2
    s_cbranch_scc1 KM_F3
    v_pk_fma_f32 v[88:89], v[34:35], v[80:81], v[88:89] op_sel:[1,0,0] op_sel_hi:[1,1,1]
    v_pk_fma_f32 v[90:91], v[34:35], v[82:83], v[90:91] op_sel:[1,0,0] op_sel_hi:[1,1,1]
    v_pk_fma_f32 v[92:93], v[50:51], v[84:85], v[92:93] op_sel:[1,0,0] op_sel_hi:[1,1,1]
    v_pk_fma_f32 v[94:95], v[50:51], v[86:87], v[94:95] op_sel:[1,0,0] op_sel_hi:[1,1,1]
KM_R3_L:
    s_waitcnt vmcnt(3)
    v_mfma_f32_4x4x4_16b_bf16 v[80:83], v[116:117], v[64:65], 0 cbsz:3 abid:4
    v_rcp_f32 v112, v112
    v_mfma_f32_4x4x4_16b_bf16 v[84:87], v[116:117], v[66:67], 0 cbsz:3 abid:4
    v_rcp_f32 v113, v113
    v_rcp_f32 v114, v114
    v_rcp_f32 v115, v115
    s_waitcnt lgkmcnt(0)
    buffer_load_dwordx4 v[64:67], v104, s[4:7], 0 offen
    ds_read_b128 v[108:111], v13 offset:10544
    v_pk_mul_f32 v[36:37], v[36:37], v[112:113]
    v_pk_mul_f32 v[52:53], v[52:53], v[114:115]
    s_bitcmp1_b32 s25, 3
    s_cbranch_scc1 KM_F4
    v_pk_fma_f32 v[88:89], v[36:37], v[80:81], v[88:89] op_sel:[0,0,0] op_sel_hi:[0,1,1]
    v_pk_fma_f32 v[90:91], v[36:37], v[82:83], v[90:91] op_sel:[0,0,0] op_sel_hi:[0,1,1]
    v_pk_fma_f32 v[92:93], v[52:53], v[84:85], v[92:93] op_sel:[0,0,0] op_sel_hi:[0,1,1]
    v_pk_fma_f32 v[94:95], v[52:53], v[86:87], v[94:95] op_sel:[0,0,0] op_sel_hi:[0,1,1]
KM_R4_L:
    s_waitcnt vmcnt(3)
    v_mfma_f32_4x4x4_16b_bf16 v[80:83], v[116:117], v[68:69], 0 cbsz:3 abid:5
    v_exp_f32 v112, v38
    v_mfma_f32_4x4x4_16b_bf16 v[84:87], v[116:117], v[70:71], 0 cbsz:3 abid:5
    v_exp_f32 v113, v39
    v_exp_f32 v114, v54
    v_exp_f32 v115, v55
    buffer_load_dwordx4 v[68:71], v105, s[4:7], 0 offen
    v_pk_fma_f32 v[112:113], v[112:113], s[88:89], s[88:89]
    v_pk_fma_f32 v[114:115], v[114:115], s[88:89], s[88:89]
    s_bitcmp1_b32 s25, 4
    s_cbranch_scc1 KM_F5
    v_pk_fma_f32 v[88:89], v[36:37], v[80:81], v[88:89] op_sel:[1,0,0] op_sel_hi:[1,1,1]
    v_pk_fma_f32 v[90:91], v[36:37], v[82:83], v[90:91] op_sel:[1,0,0] op_sel_hi:[1,1,1]
    v_pk_fma_f32 v[92:93], v[52:53], v[84:85], v[92:93] op_sel:[1,0,0] op_sel_hi:[1,1,1]
    v_pk_fma_f32 v[94:95], v[52:53], v[86:87], v[94:95] op_sel:[1,0,0] op_sel_hi:[1,1,1]
KM_R5_L:
    s_waitcnt vmcnt(3)
    v_mfma_f32_4x4x4_16b_bf16 v[80:83], v[116:117], v[72:73], 0 cbsz:3 abid:6
    v_rcp_f32 v112, v112
    v_mfma_f32_4x4x4_16b_bf16 v[84:87], v[116:117], v[74:75], 0 cbsz:3 abid:6
    v_rcp_f32 v113, v113
    v_rcp_f32 v114, v114
    v_rcp_f32 v115, v115
    buffer_load_dwordx4 v[72:75], v106, s[4:7], 0 offen
    v_pk_mul_f32 v[38:39], v[38:39], v[112:113]
    v_pk_mul_f32 v[54:55], v[54:55], v[114:115]
    s_bitcmp1_b32 s25, 5
    s_cbranch_scc1 KM_F6
    v_pk_fma_f32 v[88:89], v[38:39], v[80:81], v[88:89] op_sel:[0,0,0] op_sel_hi:[0,1,1]
    v_pk_fma_f32 v[90:91], v[38:39], v[82:83], v[90:91] op_sel:[0,0,0] op_sel_hi:[0,1,1]
    v_pk_fma_f32 v[92:93], v[54:55], v[84:85], v[92:93] op_sel:[0,0,0] op_sel_hi:[0,1,1]
    v_pk_fma_f32 v[94:95], v[54:55], v[86:87], v[94:95] op_sel:[0,0,0] op_sel_hi:[0,1,1]
KM_R6_L:
    s_setprio 0
    s_waitcnt vmcnt(3)
    v_mfma_f32_4x4x4_16b_bf16 v[80:83], v[116:117], v[76:77], 0 cbsz:3 abid:7
    v_exp_f32 v112, v40
    v_mfma_f32_4x4x4_16b_bf16 v[84:87], v[116:117], v[78:79], 0 cbsz:3 abid:7
    v_exp_f32 v113, v41
    v_exp_f32 v114, v56
    v_exp_f32 v115, v57
    buffer_load_dwordx4 v[76:79], v107, s[4:7], 0 offen
    v_pk_fma_f32 v[112:113], v[112:113], s[88:89], s[88:89]
    v_pk_fma_f32 v[114:115], v[114:115], s[88:89], s[88:89]
    s_bitcmp1_b32 s25, 6
    s_cbranch_scc1 KM_F7
    v_pk_fma_f32 v[88:89], v[38:39], v[80:81], v[88:89] op_sel:[1,0,0] op_sel_hi:[1,1,1]
    v_pk_fma_f32 v[90:91], v[38:39], v[82:83], v[90:91] op_sel:[1,0,0] op_sel_hi:[1,1,1]
    v_pk_fma_f32 v[92:93], v[54:55], v[84:85], v[92:93] op_sel:[1,0,0] op_sel_hi:[1,1,1]
    v_pk_fma_f32 v[94:95], v[54:55], v[86:87], v[94:95] op_sel:[1,0,0] op_sel_hi:[1,1,1]
KM_R7_L:
    s_waitcnt vmcnt(3)
    v_mfma_f32_4x4x4_16b_bf16 v[80:83], v[118:119], v[64:65], 0 cbsz:3 abid:0
    v_rcp_f32 v112, v112
    v_mfma_f32_4x4x4_16b_bf16 v[84:87], v[118:119], v[66:67], 0 cbsz:3 abid:0
    v_rcp_f32 v113, v113
    v_rcp_f32 v114, v114
    v_rcp_f32 v115, v115
    s_waitcnt lgkmcnt(0)
    buffer_load_dwordx4 v[64:67], v108, s[4:7], 0 offen
    v_pk_mul_f32 v[40:41], v[40:41], v[112:113]
    v_pk_mul_f32 v[56:57], v[56:57], v[114:115]
    s_bitcmp1_b32 s25, 7
    s_cbranch_scc1 KM_F8
    v_pk_fma_f32 v[88:89], v[40:41], v[80:81], v[88:89] op_sel:[0,0,0] op_sel_hi:[0,1,1]
    v_pk_fma_f32 v[90:91], v[40:41], v[82:83], v[90:91] op_sel:[0,0,0] op_sel_hi:[0,1,1]
    v_pk_fma_f32 v[92:93], v[56:57], v[84:85], v[92:93] op_sel:[0,0,0] op_sel_hi:[0,1,1]
    v_pk_fma_f32 v[94:95], v[56:57], v[86:87], v[94:95] op_sel:[0,0,0] op_sel_hi:[0,1,1]
KM_R8_L:
    s_waitcnt vmcnt(3)
    v_mfma_f32_4x4x4_16b_bf16 v[80:83], v[118:119], v[68:69], 0 cbsz:3 abid:1
    v_exp_f32 v112, v42
    v_mfma_f32_4x4x4_16b_bf16 v[84:87], v[118:119], v[70:71], 0 cbsz:3 abid:1
    v_exp_f32 v113, v43
    v_exp_f32 v114, v58
    v_exp_f32 v115, v59
    buffer_load_dwordx4 v[68:71], v109, s[4:7], 0 offen
    v_pk_fma_f32 v[112:113], v[112:113], s[88:89], s[88:89]
    v_pk_fma_f32 v[114:115], v[114:115], s[88:89], s[88:89]
    s_bitcmp1_b32 s25, 8
    s_cbranch_scc1 KM_F9
    v_pk_fma_f32 v[88:89], v[40:41], v[80:81], v[88:89] op_sel:[1,0,0] op_sel_hi:[1,1,1]
    v_pk_fma_f32 v[90:91], v[40:41], v[82:83], v[90:91] op_sel:[1,0,0] op_sel_hi:[1,1,1]
    v_pk_fma_f32 v[92:93], v[56:57], v[84:85], v[92:93] op_sel:[1,0,0] op_sel_hi:[1,1,1]
    v_pk_fma_f32 v[94:95], v[56:57], v[86:87], v[94:95] op_sel:[1,0,0] op_sel_hi:[1,1,1]
KM_R9_L:
    s_waitcnt vmcnt(3)
    v_mfma_f32_4x4x4_16b_bf16 v[80:83], v[118:119], v[72:73], 0 cbsz:3 abid:2
    v_rcp_f32 v112, v112
    v_mfma_f32_4x4x4_16b_bf16 v[84:87], v[118:119], v[74:75], 0 cbsz:3 abid:2
    v_rcp_f32 v113, v113
    v_rcp_f32 v114, v114
    v_rcp_f32 v115, v115
    buffer_load_dwordx4 v[72:75], v110, s[4:7], 0 offen
    v_pk_mul_f32 v[42:43], v[42:43], v[112:113]
    v_pk_mul_f32 v[58:59], v[58:59], v[114:115]
    s_bitcmp1_b32 s25, 9
    s_cbranch_scc1 KM_F10
    v_pk_fma_f32 v[88:89], v[42:43], v[80:81], v[88:89] op_sel:[0,0,0] op_sel_hi:[0,1,1]
    v_pk_fma_f32 v[90:91], v[42:43], v[82:83], v[90:91] op_sel:[0,0,0] op_sel_hi:[0,1,1]
    v_pk_fma_f32 v[92:93], v[58:59], v[84:85], v[92:93] op_sel:[0,0,0] op_sel_hi:[0,1,1]
    v_pk_fma_f32 v[94:95], v[58:59], v[86:87], v[94:95] op_sel:[0,0,0] op_sel_hi:[0,1,1]
KM_R10_L:
    s_waitcnt vmcnt(3)
    v_mfma_f32_4x4x4_16b_bf16 v[80:83], v[118:119], v[76:77], 0 cbsz:3 abid:3
    v_exp_f32 v112, v44
    v_mfma_f32_4x4x4_16b_bf16 v[84:87], v[118:119], v[78:79], 0 cbsz:3 abid:3
    v_exp_f32 v113, v45
    v_exp_f32 v114, v60
    v_exp_f32 v115, v61
    buffer_load_dwordx4 v[76:79], v111, s[4:7], 0 offen
    v_pk_fma_f32 v[112:113], v[112:113], s[88:89], s[88:89]
    v_pk_fma_f32 v[114:115], v[114:115], s[88:89], s[88:89]
    s_bitcmp1_b32 s25, 10
    s_cbranch_scc1 KM_F11
    v_pk_fma_f32 v[88:89], v[42:43], v[80:81], v[88:89] op_sel:[1,0,0] op_sel_hi:[1,1,1]
    v_pk_fma_f32 v[90:91], v[42:43], v[82:83], v[90:91] op_sel:[1,0,0] op_sel_hi:[1,1,1]
    v_pk_fma_f32 v[92:93], v[58:59], v[84:85], v[92:93] op_sel:[1,0,0] op_sel_hi:[1,1,1]
    v_pk_fma_f32 v[94:95], v[58:59], v[86:87], v[94:95] op_sel:[1,0,0] op_sel_hi:[1,1,1]
KM_R11_L:
    s_waitcnt vmcnt(3)
    v_mfma_f32_4x4x4_16b_bf16 v[80:83], v[118:119], v[64:65], 0 cbsz:3 abid:4
    v_rcp_f32 v112, v112
    v_mfma_f32_4x4x4_16b_bf16 v[84:87], v[118:119], v[66:67], 0 cbsz:3 abid:4
    v_rcp_f32 v113, v113
    v_rcp_f32 v114, v114
    v_rcp_f32 v115, v115
    v_pk_mul_f32 v[44:45], v[44:45], v[112:113]
    v_pk_mul_f32 v[60:61], v[60:61], v[114:115]
    s_bitcmp1_b32 s25, 11
    s_cbranch_scc1 KM_F12
    v_pk_fma_f32 v[88:89], v[44:45], v[80:81], v[88:89] op_sel:[0,0,0] op_sel_hi:[0,1,1]
    v_pk_fma_f32 v[90:91], v[44:45], v[82:83], v[90:91] op_sel:[0,0,0] op_sel_hi:[0,1,1]
    v_pk_fma_f32 v[92:93], v[60:61], v[84:85], v[92:93] op_sel:[0,0,0] op_sel_hi:[0,1,1]
    v_pk_fma_f32 v[94:95], v[60:61], v[86:87], v[94:95] op_sel:[0,0,0] op_sel_hi:[0,1,1]
KM_R12_L:
    s_waitcnt vmcnt(2)
    v_mfma_f32_4x4x4_16b_bf16 v[80:83], v[118:119], v[68:69], 0 cbsz:3 abid:5
    v_exp_f32 v112, v46
    v_mfma_f32_4x4x4_16b_bf16 v[84:87], v[118:119], v[70:71], 0 cbsz:3 abid:5
    v_exp_f32 v113, v47
    v_exp_f32 v114, v62
    v_exp_f32 v115, v63
    v_pk_fma_f32 v[112:113], v[112:113], s[88:89], s[88:89]
    v_pk_fma_f32 v[114:115], v[114:115], s[88:89], s[88:89]
    s_bitcmp1_b32 s25, 12
    s_cbranch_scc1 KM_F13
    v_pk_fma_f32 v[88:89], v[44:45], v[80:81], v[88:89] op_sel:[1,0,0] op_sel_hi:[1,1,1]
    v_pk_fma_f32 v[90:91], v[44:45], v[82:83], v[90:91] op_sel:[1,0,0] op_sel_hi:[1,1,1]
    v_pk_fma_f32 v[92:93], v[60:61], v[84:85], v[92:93] op_sel:[1,0,0] op_sel_hi:[1,1,1]
    v_pk_fma_f32 v[94:95], v[60:61], v[86:87], v[94:95] op_sel:[1,0,0] op_sel_hi:[1,1,1]
KM_R13_L:
    s_waitcnt vmcnt(1)
    v_mfma_f32_4x4x4_16b_bf16 v[80:83], v[118:119], v[72:73], 0 cbsz:3 abid:6
    v_rcp_f32 v112, v112
    v_mfma_f32_4x4x4_16b_bf16 v[84:87], v[118:119], v[74:75], 0 cbsz:3 abid:6
    v_rcp_f32 v113, v113
    v_rcp_f32 v114, v114
    v_rcp_f32 v115, v115
    v_pk_mul_f32 v[46:47], v[46:47], v[112:113]
    v_pk_mul_f32 v[62:63], v[62:63], v[114:115]
    s_bitcmp1_b32 s25, 13
    s_cbranch_scc1 KM_F14
    v_pk_fma_f32 v[88:89], v[46:47], v[80:81], v[88:89] op_sel:[0,0,0] op_sel_hi:[0,1,1]
    v_pk_fma_f32 v[90:91], v[46:47], v[82:83], v[90:91] op_sel:[0,0,0] op_sel_hi:[0,1,1]
    v_pk_fma_f32 v[92:93], v[62:63], v[84:85], v[92:93] op_sel:[0,0,0] op_sel_hi:[0,1,1]
    v_pk_fma_f32 v[94:95], v[62:63], v[86:87], v[94:95] op_sel:[0,0,0] op_sel_hi:[0,1,1]
KM_R14_L:
    s_waitcnt vmcnt(0)
    v_mfma_f32_4x4x4_16b_bf16 v[80:83], v[118:119], v[76:77], 0 cbsz:3 abid:7
    v_mfma_f32_4x4x4_16b_bf16 v[84:87], v[118:119], v[78:79], 0 cbsz:3 abid:7
    s_nop 1
    s_bitcmp1_b32 s25, 14
    s_cbranch_scc1 KM_F15
    v_pk_fma_f32 v[88:89], v[46:47], v[80:81], v[88:89] op_sel:[1,0,0] op_sel_hi:[1,1,1]
    v_pk_fma_f32 v[90:91], v[46:47], v[82:83], v[90:91] op_sel:[1,0,0] op_sel_hi:[1,1,1]
    v_pk_fma_f32 v[92:93], v[62:63], v[84:85], v[92:93] op_sel:[1,0,0] op_sel_hi:[1,1,1]
    v_pk_fma_f32 v[94:95], v[62:63], v[86:87], v[94:95] op_sel:[1,0,0] op_sel_hi:[1,1,1]
KM_R15_L:
    v_add_u32_dpp v14, v10, v4 row_newbcast:15 row_mask:0xf bank_mask:0xf
    v_cvt_f64_f32 v[96:97], v88
    ds_add_f64 v14, v[96:97] offset:0
    v_cvt_f64_f32 v[98:99], v89
    ds_add_f64 v14, v[98:99] offset:272
    v_cvt_f64_f32 v[100:101], v90
    ds_add_f64 v14, v[100:101] offset:544
    v_cvt_f64_f32 v[102:103], v91
    ds_add_f64 v14, v[102:103] offset:816
    v_cvt_f64_f32 v[96:97], v92
    ds_add_f64 v14, v[96:97] offset:1088
    v_cvt_f64_f32 v[98:99], v93
    ds_add_f64 v14, v[98:99] offset:1360
    v_cvt_f64_f32 v[100:101], v94
    ds_add_f64 v14, v[100:101] offset:1632
    v_cvt_f64_f32 v[102:103], v95
    ds_add_f64 v14, v[102:103] offset:1904
    s_branch KM_DONE
KM_F1:
    v_add_u32_dpp v14, v10, v4 row_newbcast:0 row_mask:0xf bank_mask:0xf
    v_cvt_f64_f32 v[96:97], v88
    ds_add_f64 v14, v[96:97] offset:0
    v_cvt_f64_f32 v[98:99], v89
    ds_add_f64 v14, v[98:99] offset:272
    v_cvt_f64_f32 v[100:101], v90
    ds_add_f64 v14, v[100:101] offset:544
    v_cvt_f64_f32 v[102:103], v91
    ds_add_f64 v14, v[102:103] offset:816
    v_cvt_f64_f32 v[96:97], v92
    ds_add_f64 v14, v[96:97] offset:1088
    v_cvt_f64_f32 v[98:99], v93
    ds_add_f64 v14, v[98:99] offset:1360
    v_cvt_f64_f32 v[100:101], v94
    ds_add_f64 v14, v[100:101] offset:1632
    v_cvt_f64_f32 v[102:103], v95
    ds_add_f64 v14, v[102:103] offset:1904
    v_pk_mul_f32 v[88:89], v[32:33], v[80:81] op_sel:[1,0] op_sel_hi:[1,1]
    v_pk_mul_f32 v[90:91], v[32:33], v[82:83] op_sel:[1,0] op_sel_hi:[1,1]
    v_pk_mul_f32 v[92:93], v[48:49], v[84:85] op_sel:[1,0] op_sel_hi:[1,1]
    v_pk_mul_f32 v[94:95], v[48:49], v[86:87] op_sel:[1,0] op_sel_hi:[1,1]
    s_branch KM_R1
KM_F2:
    v_add_u32_dpp v14, v10, v4 row_newbcast:1 row_mask:0xf bank_mask:0xf
    v_cvt_f64_f32 v[96:97], v88
    ds_add_f64 v14, v[96:97] offset:0
    v_cvt_f64_f32 v[98:99], v89
    ds_add_f64 v14, v[98:99] offset:272
    v_cvt_f64_f32 v[100:101], v90
    ds_add_f64 v14, v[100:101] offset:544
    v_cvt_f64_f32 v[102:103], v91
    ds_add_f64 v14, v[102:103] offset:816
    v_cvt_f64_f32 v[96:97], v92
    ds_add_f64 v14, v[96:97] offset:1088
    v_cvt_f64_f32 v[98:99], v93
    ds_add_f64 v14, v[98:99] offset:1360
    v_cvt_f64_f32 v[100:101], v94
    ds_add_f64 v14, v[100:101] offset:1632
    v_cvt_f64_f32 v[102:103], v95
    ds_add_f64 v14, v[102:103] offset:1904
    v_pk_mul_f32 v[88:89], v[34:35], v[80:81] op_sel:[0,0] op_sel_hi:[0,1]
    v_pk_mul_f32 v[90:91], v[34:35], v[82:83] op_sel:[0,0] op_sel_hi:[0,1]
    v_pk_mul_f32 v[92:93], v[50:51], v[84:85] op_sel:[0,0] op_sel_hi:[0,1]
    v_pk_mul_f32 v[94:95], v[50:51], v[86:87] op_sel:[0,0] op_sel_hi:[0,1]
    s_branch KM_R2
KM_F3:
    v_add_u32_dpp v14, v10, v4 row_newbcast:2 row_mask:0xf bank_mask:0xf
    v_cvt_f64_f32 v[96:97], v88
    ds_add_f64 v14, v[96:97] offset:0
    v_cvt_f64_f32 v[98:99], v89
    ds_add_f64 v14, v[98:99] offset:272
    v_cvt_f64_f32 v[100:101], v90
    ds_add_f64 v14, v[100:101] offset:544
    v_cvt_f64_f32 v[102:103], v91
    ds_add_f64 v14, v[102:103] offset:816
    v_cvt_f64_f32 v[96:97], v92
    ds_add_f64 v14, v[96:97] offset:1088
    v_cvt_f64_f32 v[98:99], v93
    ds_add_f64 v14, v[98:99] offset:1360
    v_cvt_f64_f32 v[100:101], v94
    ds_add_f64 v14, v[100:101] offset:1632
    v_cvt_f64_f32 v[102:103], v95
    ds_add_f64 v14, v[102:103] offset:1904
    v_pk_mul_f32 v[88:89], v[34:35], v[80:81] op_sel:[1,0] op_sel_hi:[1,1]
    v_pk_mul_f32 v[90:91], v[34:35], v[82:83] op_sel:[1,0] op_sel_hi:[1,1]
    v_pk_mul_f32 v[92:93], v[50:51], v[84:85] op_sel:[1,0] op_sel_hi:[1,1]
    v_pk_mul_f32 v[94:95], v[50:51], v[86:87] op_sel:[1,0] op_sel_hi:[1,1]
    s_cmp_lt_u32 s24, s22
    s_cbranch_scc1 KM_R3_0
    s_cmp_lt_u32 s24, s23
    s_cbranch_scc1 KM_R3_1
    s_branch KM_R3_L
KM_F4:
    v_add_u32_dpp v14, v10, v4 row_newbcast:3 row_mask:0xf bank_mask:0xf
    v_cvt_f64_f32 v[96:97], v88
    ds_add_f64 v14, v[96:97] offset:0
    v_cvt_f64_f32 v[98:99], v89
    ds_add_f64 v14, v[98:99] offset:272
    v_cvt_f64_f32 v[100:101], v90
    ds_add_f64 v14, v[100:101] offset:544
    v_cvt_f64_f32 v[102:103], v91
    ds_add_f64 v14, v[102:103] offset:816
    v_cvt_f64_f32 v[96:97], v92
    ds_add_f64 v14, v[96:97] offset:1088
    v_cvt_f64_f32 v[98:99], v93
    ds_add_f64 v14, v[98:99] offset:1360
    v_cvt_f64_f32 v[100:101], v94
    ds_add_f64 v14, v[100:101] offset:1632
    v_cvt_f64_f32 v[102:103], v95
    ds_add_f64 v14, v[102:103] offset:1904
    v_pk_mul_f32 v[88:89], v[36:37], v[80:81] op_sel:[0,0] op_sel_hi:[0,1]
    v_pk_mul_f32 v[90:91], v[36:37], v[82:83] op_sel:[0,0] op_sel_hi:[0,1]
    v_pk_mul_f32 v[92:93], v[52:53], v[84:85] op_sel:[0,0] op_sel_hi:[0,1]
    v_pk_mul_f32 v[94:95], v[52:53], v[86:87] op_sel:[0,0] op_sel_hi:[0,1]
    s_cmp_lt_u32 s24, s22
    s_cbranch_scc1 KM_R4_0
    s_cmp_lt_u32 s24, s23
    s_cbranch_scc1 KM_R4_1
    s_branch KM_R4_L
KM_F5:
    v_add_u32_dpp v14, v10, v4 row_newbcast:4 row_mask:0xf bank_mask:0xf
    v_cvt_f64_f32 v[96:97], v88
    ds_add_f64 v14, v[96:97] offset:0
    v_cvt_f64_f32 v[98:99], v89
    ds_add_f64 v14, v[98:99] offset:272
    v_cvt_f64_f32 v[100:101], v90
    ds_add_f64 v14, v[100:101] offset:544
    v_cvt_f64_f32 v[102:103], v91
    ds_add_f64 v14, v[102:103] offset:816
    v_cvt_f64_f32 v[96:97], v92
    ds_add_f64 v14, v[96:97] offset:1088
    v_cvt_f64_f32 v[98:99], v93
    ds_add_f64 v14, v[98:99] offset:1360
    v_cvt_f64_f32 v[100:101], v94
    ds_add_f64 v14, v[100:101] offset:1632
    v_cvt_f64_f32 v[102:103], v95
    ds_add_f64 v14, v[102:103] offset:1904
    v_pk_mul_f32 v[88:89], v[36:37], v[80:81] op_sel:[1,0] op_sel_hi:[1,1]
    v_pk_mul_f32 v[90:91], v[36:37], v[82:83] op_sel:[1,0] op_sel_hi:[1,1]
    v_pk_mul_f32 v[92:93], v[52:53], v[84:85] op_sel:[1,0] op_sel_hi:[1,1]
    v_pk_mul_f32 v[94:95], v[52:53], v[86:87] op_sel:[1,0] op_sel_hi:[1,1]
    s_cmp_lt_u32 s24, s22
    s_cbranch_scc1 KM_R5_0
    s_cmp_lt_u32 s24, s23
    s_cbranch_scc1 KM_R5_1
    s_branch KM_R5_L
KM_F6:
    v_add_u32_dpp v14, v10, v4 row_newbcast:5 row_mask:0xf bank_mask:0xf
    v_cvt_f64_f32 v[96:97], v88
    ds_add_f64 v14, v[96:97] offset:0
    v_cvt_f64_f32 v[98:99], v89
    ds_add_f64 v14, v[98:99] offset:272
    v_cvt_f64_f32 v[100:101], v90
    ds_add_f64 v14, v[100:101] offset:544
    v_cvt_f64_f32 v[102:103], v91
    ds_add_f64 v14, v[102:103] offset:816
    v_cvt_f64_f32 v[96:97], v92
    ds_add_f64 v14, v[96:97] offset:1088
    v_cvt_f64_f32 v[98:99], v93
    ds_add_f64 v14, v[98:99] offset:1360
    v_cvt_f64_f32 v[100:101], v94
    ds_add_f64 v14, v[100:101] offset:1632
    v_cvt_f64_f32 v[102:103], v95
    ds_add_f64 v14, v[102:103] offset:1904
    v_pk_mul_f32 v[88:89], v[38:39], v[80:81] op_sel:[0,0] op_sel_hi:[0,1]
    v_pk_mul_f32 v[90:91], v[38:39], v[82:83] op_sel:[0,0] op_sel_hi:[0,1]
    v_pk_mul_f32 v[92:93], v[54:55], v[84:85] op_sel:[0,0] op_sel_hi:[0,1]
    v_pk_mul_f32 v[94:95], v[54:55], v[86:87] op_sel:[0,0] op_sel_hi:[0,1]
    s_cmp_lt_u32 s24, s22
    s_cbranch_scc1 KM_R6_0
    s_cmp_lt_u32 s24, s23
    s_cbranch_scc1 KM_R6_1
    s_branch KM_R6_L
KM_F7:
    v_add_u32_dpp v14, v10, v4 row_newbcast:6 row_mask:0xf bank_mask:0xf
    v_cvt_f64_f32 v[96:97], v88
    ds_add_f64 v14, v[96:97] offset:0
    v_cvt_f64_f32 v[98:99], v89
    ds_add_f64 v14, v[98:99] offset:272
    v_cvt_f64_f32 v[100:101], v90
    ds_add_f64 v14, v[100:101] offset:544
    v_cvt_f64_f32 v[102:103], v91
    ds_add_f64 v14, v[102:103] offset:816
    v_cvt_f64_f32 v[96:97], v92
    ds_add_f64 v14, v[96:97] offset:1088
    v_cvt_f64_f32 v[98:99], v93
    ds_add_f64 v14, v[98:99] offset:1360
    v_cvt_f64_f32 v[100:101], v94
    ds_add_f64 v14, v[100:101] offset:1632
    v_cvt_f64_f32 v[102:103], v95
    ds_add_f64 v14, v[102:103] offset:1904
    v_pk_mul_f32 v[88:89], v[38:39], v[80:81] op_sel:[1,0] op_sel_hi:[1,1]
    v_pk_mul_f32 v[90:91], v[38:39], v[82:83] op_sel:[1,0] op_sel_hi:[1,1]
    v_pk_mul_f32 v[92:93], v[54:55], v[84:85] op_sel:[1,0] op_sel_hi:[1,1]
    v_pk_mul_f32 v[94:95], v[54:55], v[86:87] op_sel:[1,0] op_sel_hi:[1,1]
    s_cmp_lt_u32 s24, s22
    s_cbranch_scc1 KM_R7_0
    s_cmp_lt_u32 s24, s23
    s_cbranch_scc1 KM_R7_1
    s_branch KM_R7_L
KM_F8:
    v_add_u32_dpp v14, v10, v4 row_newbcast:7 row_mask:0xf bank_mask:0xf
    v_cvt_f64_f32 v[96:97], v88
    ds_add_f64 v14, v[96:97] offset:0
    v_cvt_f64_f32 v[98:99], v89
    ds_add_f64 v14, v[98:99] offset:272
    v_cvt_f64_f32 v[100:101], v90
    ds_add_f64 v14, v[100:101] offset:544
    v_cvt_f64_f32 v[102:103], v91
    ds_add_f64 v14, v[102:103] offset:816
    v_cvt_f64_f32 v[96:97], v92
    ds_add_f64 v14, v[96:97] offset:1088
    v_cvt_f64_f32 v[98:99], v93
    ds_add_f64 v14, v[98:99] offset:1360
    v_cvt_f64_f32 v[100:101], v94
    ds_add_f64 v14, v[100:101] offset:1632
    v_cvt_f64_f32 v[102:103], v95
    ds_add_f64 v14, v[102:103] offset:1904
    v_pk_mul_f32 v[88:89], v[40:41], v[80:81] op_sel:[0,0] op_sel_hi:[0,1]
    v_pk_mul_f32 v[90:91], v[40:41], v[82:83] op_sel:[0,0] op_sel_hi:[0,1]
    v_pk_mul_f32 v[92:93], v[56:57], v[84:85] op_sel:[0,0] op_sel_hi:[0,1]
    v_pk_mul_f32 v[94:95], v[56:57], v[86:87] op_sel:[0,0] op_sel_hi:[0,1]
    s_cmp_lt_u32 s24, s22
    s_cbranch_scc1 KM_R8_0
    s_cmp_lt_u32 s24, s23
    s_cbranch_scc1 KM_R8_1
    s_branch KM_R8_L
KM_F9:
    v_add_u32_dpp v14, v10, v4 row_newbcast:8 row_mask:0xf bank_mask:0xf
    v_cvt_f64_f32 v[96:97], v88
    ds_add_f64 v14, v[96:97] offset:0
    v_cvt_f64_f32 v[98:99], v89
    ds_add_f64 v14, v[98:99] offset:272
    v_cvt_f64_f32 v[100:101], v90
    ds_add_f64 v14, v[100:101] offset:544
    v_cvt_f64_f32 v[102:103], v91
    ds_add_f64 v14, v[102:103] offset:816
    v_cvt_f64_f32 v[96:97], v92
    ds_add_f64 v14, v[96:97] offset:1088
    v_cvt_f64_f32 v[98:99], v93
    ds_add_f64 v14, v[98:99] offset:1360
    v_cvt_f64_f32 v[100:101], v94
    ds_add_f64 v14, v[100:101] offset:1632
    v_cvt_f64_f32 v[102:103], v95
    ds_add_f64 v14, v[102:103] offset:1904
    v_pk_mul_f32 v[88:89], v[40:41], v[80:81] op_sel:[1,0] op_sel_hi:[1,1]
    v_pk_mul_f32 v[90:91], v[40:41], v[82:83] op_sel:[1,0] op_sel_hi:[1,1]
    v_pk_mul_f32 v[92:93], v[56:57], v[84:85] op_sel:[1,0] op_sel_hi:[1,1]
    v_pk_mul_f32 v[94:95], v[56:57], v[86:87] op_sel:[1,0] op_sel_hi:[1,1]
    s_cmp_lt_u32 s24, s22
    s_cbranch_scc1 KM_R9_0
    s_cmp_lt_u32 s24, s23
    s_cbranch_scc1 KM_R9_1
    s_branch KM_R9_L
KM_F10:
    v_add_u32_dpp v14, v10, v4 row_newbcast:9 row_mask:0xf bank_mask:0xf
    v_cvt_f64_f32 v[96:97], v88
    ds_add_f64 v14, v[96:97] offset:0
    v_cvt_f64_f32 v[98:99], v89
    ds_add_f64 v14, v[98:99] offset:272
    v_cvt_f64_f32 v[100:101], v90
    ds_add_f64 v14, v[100:101] offset:544
    v_cvt_f64_f32 v[102:103], v91
    ds_add_f64 v14, v[102:103] offset:816
    v_cvt_f64_f32 v[96:97], v92
    ds_add_f64 v14, v[96:97] offset:1088
    v_cvt_f64_f32 v[98:99], v93
    ds_add_f64 v14, v[98:99] offset:1360
    v_cvt_f64_f32 v[100:101], v94
    ds_add_f64 v14, v[100:101] offset:1632
    v_cvt_f64_f32 v[102:103], v95
    ds_add_f64 v14, v[102:103] offset:1904
    v_pk_mul_f32 v[88:89], v[42:43], v[80:81] op_sel:[0,0] op_sel_hi:[0,1]
    v_pk_mul_f32 v[90:91], v[42:43], v[82:83] op_sel:[0,0] op_sel_hi:[0,1]
    v_pk_mul_f32 v[92:93], v[58:59], v[84:85] op_sel:[0,0] op_sel_hi:[0,1]
    v_pk_mul_f32 v[94:95], v[58:59], v[86:87] op_sel:[0,0] op_sel_hi:[0,1]
    s_cmp_lt_u32 s24, s22
    s_cbranch_scc1 KM_R10_0
    s_cmp_lt_u32 s24, s23
    s_cbranch_scc1 KM_R10_1
    s_branch KM_R10_L
KM_F11:
    v_add_u32_dpp v14, v10, v4 row_newbcast:10 row_mask:0xf bank_mask:0xf
    v_cvt_f64_f32 v[96:97], v88
    ds_add_f64 v14, v[96:97] offset:0
    v_cvt_f64_f32 v[98:99], v89
    ds_add_f64 v14, v[98:99] offset:272
    v_cvt_f64_f32 v[100:101], v90
    ds_add_f64 v14, v[100:101] offset:544
    v_cvt_f64_f32 v[102:103], v91
    ds_add_f64 v14, v[102:103] offset:816
    v_cvt_f64_f32 v[96:97], v92
    ds_add_f64 v14, v[96:97] offset:1088
    v_cvt_f64_f32 v[98:99], v93
    ds_add_f64 v14, v[98:99] offset:1360
    v_cvt_f64_f32 v[100:101], v94
    ds_add_f64 v14, v[100:101] offset:1632
    v_cvt_f64_f32 v[102:103], v95
    ds_add_f64 v14, v[102:103] offset:1904
    v_pk_mul_f32 v[88:89], v[42:43], v[80:81] op_sel:[1,0] op_sel_hi:[1,1]
    v_pk_mul_f32 v[90:91], v[42:43], v[82:83] op_sel:[1,0] op_sel_hi:[1,1]
    v_pk_mul_f32 v[92:93], v[58:59], v[84:85] op_sel:[1,0] op_sel_hi:[1,1]
    v_pk_mul_f32 v[94:95], v[58:59], v[86:87] op_sel:[1,0] op_sel_hi:[1,1]
    s_cmp_lt_u32 s24, s22
    s_cbranch_scc1 KM_R11_0
    s_cmp_lt_u32 s24, s23
    s_cbranch_scc1 KM_R11_1
    s_branch KM_R11_L
KM_F12:
    v_add_u32_dpp v14, v10, v4 row_newbcast:11 row_mask:0xf bank_mask:0xf
    v_cvt_f64_f32 v[96:97], v88
    ds_add_f64 v14, v[96:97] offset:0
    v_cvt_f64_f32 v[98:99], v89
    ds_add_f64 v14, v[98:99] offset:272
    v_cvt_f64_f32 v[100:101], v90
    ds_add_f64 v14, v[100:101] offset:544
    v_cvt_f64_f32 v[102:103], v91
    ds_add_f64 v14, v[102:103] offset:816
    v_cvt_f64_f32 v[96:97], v92
    ds_add_f64 v14, v[96:97] offset:1088
    v_cvt_f64_f32 v[98:99], v93
    ds_add_f64 v14, v[98:99] offset:1360
    v_cvt_f64_f32 v[100:101], v94
    ds_add_f64 v14, v[100:101] offset:1632
    v_cvt_f64_f32 v[102:103], v95
    ds_add_f64 v14, v[102:103] offset:1904
    v_pk_mul_f32 v[88:89], v[44:45], v[80:81] op_sel:[0,0] op_sel_hi:[0,1]
    v_pk_mul_f32 v[90:91], v[44:45], v[82:83] op_sel:[0,0] op_sel_hi:[0,1]
    v_pk_mul_f32 v[92:93], v[60:61], v[84:85] op_sel:[0,0] op_sel_hi:[0,1]
    v_pk_mul_f32 v[94:95], v[60:61], v[86:87] op_sel:[0,0] op_sel_hi:[0,1]
    s_cmp_lt_u32 s24, s22
    s_cbranch_scc1 KM_R12_0
    s_cmp_lt_u32 s24, s23
    s_cbranch_scc1 KM_R12_1
    s_branch KM_R12_L
KM_F13:
    v_add_u32_dpp v14, v10, v4 row_newbcast:12 row_mask:0xf bank_mask:0xf
    v_cvt_f64_f32 v[96:97], v88
    ds_add_f64 v14, v[96:97] offset:0
    v_cvt_f64_f32 v[98:99], v89
    ds_add_f64 v14, v[98:99] offset:272
    v_cvt_f64_f32 v[100:101], v90
    ds_add_f64 v14, v[100:101] offset:544
    v_cvt_f64_f32 v[102:103], v91
    ds_add_f64 v14, v[102:103] offset:816
    v_cvt_f64_f32 v[96:97], v92
    ds_add_f64 v14, v[96:97] offset:1088
    v_cvt_f64_f32 v[98:99], v93
    ds_add_f64 v14, v[98:99] offset:1360
    v_cvt_f64_f32 v[100:101], v94
    ds_add_f64 v14, v[100:101] offset:1632
    v_cvt_f64_f32 v[102:103], v95
    ds_add_f64 v14, v[102:103] offset:1904
    v_pk_mul_f32 v[88:89], v[44:45], v[80:81] op_sel:[1,0] op_sel_hi:[1,1]
    v_pk_mul_f32 v[90:91], v[44:45], v[82:83] op_sel:[1,0] op_sel_hi:[1,1]
    v_pk_mul_f32 v[92:93], v[60:61], v[84:85] op_sel:[1,0] op_sel_hi:[1,1]
    v_pk_mul_f32 v[94:95], v[60:61], v[86:87] op_sel:[1,0] op_sel_hi:[1,1]
    s_cmp_lt_u32 s24, s22
    s_cbranch_scc1 KM_R13_0
    s_cmp_lt_u32 s24, s23
    s_cbranch_scc1 KM_R13_1
    s_branch KM_R13_L
KM_F14:
    v_add_u32_dpp v14, v10, v4 row_newbcast:13 row_mask:0xf bank_mask:0xf
    v_cvt_f64_f32 v[96:97], v88
    ds_add_f64 v14, v[96:97] offset:0
    v_cvt_f64_f32 v[98:99], v89
    ds_add_f64 v14, v[98:99] offset:272
    v_cvt_f64_f32 v[100:101], v90
    ds_add_f64 v14, v[100:101] offset:544
    v_cvt_f64_f32 v[102:103], v91
    ds_add_f64 v14, v[102:103] offset:816
    v_cvt_f64_f32 v[96:97], v92
    ds_add_f64 v14, v[96:97] offset:1088
    v_cvt_f64_f32 v[98:99], v93
    ds_add_f64 v14, v[98:99] offset:1360
    v_cvt_f64_f32 v[100:101], v94
    ds_add_f64 v14, v[100:101] offset:1632
    v_cvt_f64_f32 v[102:103], v95
    ds_add_f64 v14, v[102:103] offset:1904
    v_pk_mul_f32 v[88:89], v[46:47], v[80:81] op_sel:[0,0] op_sel_hi:[0,1]
    v_pk_mul_f32 v[90:91], v[46:47], v[82:83] op_sel:[0,0] op_sel_hi:[0,1]
    v_pk_mul_f32 v[92:93], v[62:63], v[84:85] op_sel:[0,0] op_sel_hi:[0,1]
    v_pk_mul_f32 v[94:95], v[62:63], v[86:87] op_sel:[0,0] op_sel_hi:[0,1]
    s_cmp_lt_u32 s24, s22
    s_cbranch_scc1 KM_R14_0
    s_cmp_lt_u32 s24, s23
    s_cbranch_scc1 KM_R14_1
    s_branch KM_R14_L
KM_F15:
    v_add_u32_dpp v14, v10, v4 row_newbcast:14 row_mask:0xf bank_mask:0xf
    v_cvt_f64_f32 v[96:97], v88
    ds_add_f64 v14, v[96:97] offset:0
    v_cvt_f64_f32 v[98:99], v89
    ds_add_f64 v14, v[98:99] offset:272
    v_cvt_f64_f32 v[100:101], v90
    ds_add_f64 v14, v[100:101] offset:544
    v_cvt_f64_f32 v[102:103], v91
    ds_add_f64 v14, v[102:103] offset:816
    v_cvt_f64_f32 v[96:97], v92
    ds_add_f64 v14, v[96:97] offset:1088
    v_cvt_f64_f32 v[98:99], v93
    ds_add_f64 v14, v[98:99] offset:1360
    v_cvt_f64_f32 v[100:101], v94
    ds_add_f64 v14, v[100:101] offset:1632
    v_cvt_f64_f32 v[102:103], v95
    ds_add_f64 v14, v[102:103] offset:1904
    v_pk_mul_f32 v[88:89], v[46:47], v[80:81] op_sel:[1,0] op_sel_hi:[1,1]
    v_pk_mul_f32 v[90:91], v[46:47], v[82:83] op_sel:[1,0] op_sel_hi:[1,1]
    v_pk_mul_f32 v[92:93], v[62:63], v[84:85] op_sel:[1,0] op_sel_hi:[1,1]
    v_pk_mul_f32 v[94:95], v[62:63], v[86:87] op_sel:[1,0] op_sel_hi:[1,1]
    s_cmp_lt_u32 s24, s22
    s_cbranch_scc1 KM_R15_0
    s_cmp_lt_u32 s24, s23
    s_cbranch_scc1 KM_R15_1
    s_branch KM_R15_L
KB_NARROW:
    s_mov_b32 s21, 0
    s_branch KB_ROUND
KB_NEXT:
    s_lshl_b32 s29, 8, s21
    s_add_u32 s20, s20, s29
KB_ROUND:
    s_waitcnt vmcnt(0) lgkmcnt(0)
    s_barrier
    v_and_b32 v112, 0xff, v0
    v_lshlrev_b32 v112, 2, v112
    v_mov_b32 v113, 0
    v_mov_b32 v114, 16
    ds_write_b32 v112, v113 offset:0
    ds_write2_b32 v9, v114, v113 offset0:0 offset1:1
    v_and_b32 v115, 15, v0
    s_add_u32 s29, s21, 3
    v_lshrrev_b32 v116, s29, v115
    v_lshl_add_u32 v115, v116, 20, v115
    v_add_u32 v115, s20, v115
    v_lshrrev_b32 v92, 4, v0
    v_mul_u32_u24 v92, 121344, v92
    v_add_u32 v93, 30336, v92
    v_add_u32 v94, 60672, v92
    v_add_u32 v95, 91008, v92
    s_waitcnt lgkmcnt(0)
    s_barrier
    s_branch KB_ROUND0
KM_DONE:
    s_setprio 0
    s_cmp_eq_u32 s28, 0
    s_cbranch_scc0 KB_NEXT
    s_cmp_ge_u32 s19, 10
    s_cbranch_scc0 KE_MIX
    s_waitcnt lgkmcnt(0)
    s_barrier
    s_branch KE_FIN
KE_MIX:
    v_and_b32 v1, 63, v0
    v_lshlrev_b32 v2, 4, v1
    ds_read_b128 v[32:35], v2 offset:2304
    ds_read_b128 v[36:39], v2 offset:3328
    ds_read_b128 v[40:43], v2 offset:4352
    ds_read_b128 v[44:47], v2 offset:5376
    ds_read_b128 v[48:51], v2 offset:6400
    ds_read_b128 v[52:55], v2 offset:7424
    ds_read_b128 v[56:59], v2 offset:8448
    ds_read_b128 v[60:63], v2 offset:9472
    v_bfe_u32 v2, v1, 2, 2
    v_mul_u32_u24 v2, 2176, v2
    v_and_b32 v3, 3, v1
    v_mul_u32_u24 v3, 272, v3
    v_lshrrev_b32 v4, 4, v1
    v_lshlrev_b32 v5, 6, v4
    v_add3_u32 v2, v2, v3, v5
    s_mul_i32 s70, s19, 8704
    s_add_u32 s70, s70, 73984
    v_add_u32 v2, s70, v2
    v_and_b32 v3, 15, v1
    v_lshlrev_b32 v3, 4, v3
    v_lshl_add_u32 v3, v4, 17, v3
    s_lshl_b32 s70, s19, 19
    s_lshl_b32 s71, s18, 9
    s_add_u32 s70, s70, s71
    v_add_u32 v3, s70, v3
    s_lshr_b32 s72, s18, 4
    s_lshl_b32 s72, s72, 9
    s_sub_u32 s72, s72, s71
    s_and_b32 s73, s18, 15
    s_cselect_b32 s72, 0x40000000, s72
    s_cmp_eq_u32 s19, 9
    s_cselect_b32 s72, s72, 0
    v_cmp_le_u32 vcc, 48, v1
    v_add_u32 v4, s72, v3
    s_nop 0
    v_cndmask_b32 v3, v3, v4, vcc
    s_waitcnt lgkmcnt(0)
    s_barrier
    ds_read_b128 v[80:83], v2 offset:0
    ds_read_b128 v[84:87], v2 offset:16
    ds_read_b128 v[88:91], v2 offset:32
    ds_read_b128 v[92:95], v2 offset:48
    ds_read_b128 v[96:99], v2 offset:1088
    ds_read_b128 v[100:103], v2 offset:1104
    ds_read_b128 v[104:107], v2 offset:1120
    ds_read_b128 v[108:111], v2 offset:1136
    s_waitcnt lgkmcnt(7)
    v_cvt_f32_f64 v16, v[80:81]
    v_cvt_f32_f64 v17, v[82:83]
    v_cvt_pk_bf16_f32 v8, v16, v17
    s_waitcnt lgkmcnt(6)
    v_cvt_f32_f64 v18, v[84:85]
    v_cvt_f32_f64 v19, v[86:87]
    v_cvt_pk_bf16_f32 v9, v18, v19
    s_waitcnt lgkmcnt(5)
    v_cvt_f32_f64 v20, v[88:89]
    v_cvt_f32_f64 v21, v[90:91]
    v_cvt_pk_bf16_f32 v10, v20, v21
    s_waitcnt lgkmcnt(4)
    v_cvt_f32_f64 v22, v[92:93]
    v_cvt_f32_f64 v23, v[94:95]
    v_cvt_pk_bf16_f32 v11, v22, v23
    s_waitcnt lgkmcnt(3)
    v_cvt_f32_f64 v24, v[96:97]
    v_cvt_f32_f64 v25, v[98:99]
    v_cvt_pk_bf16_f32 v12, v24, v25
    v_mfma_f32_16x16x32_bf16 v[80:83], v[8:11], v[32:35], 0
    s_waitcnt lgkmcnt(2)
    v_cvt_f32_f64 v26, v[100:101]
    v_cvt_f32_f64 v27, v[102:103]
    v_cvt_pk_bf16_f32 v13, v26, v27
    v_mfma_f32_16x16x32_bf16 v[84:87], v[8:11], v[36:39], 0
    s_waitcnt lgkmcnt(1)
    v_cvt_f32_f64 v28, v[104:105]
    v_cvt_f32_f64 v29, v[106:107]
    v_cvt_pk_bf16_f32 v14, v28, v29
    v_mfma_f32_16x16x32_bf16 v[88:91], v[8:11], v[40:43], 0
    s_waitcnt lgkmcnt(0)
    v_cvt_f32_f64 v30, v[108:109]
    v_cvt_f32_f64 v31, v[110:111]
    v_cvt_pk_bf16_f32 v15, v30, v31
    v_mfma_f32_16x16x32_bf16 v[92:95], v[8:11], v[44:47], 0
    s_nop 0
    v_mfma_f32_16x16x32_bf16 v[80:83], v[12:15], v[48:51], v[80:83]
    v_mfma_f32_16x16x32_bf16 v[84:87], v[12:15], v[52:55], v[84:87]
    v_mfma_f32_16x16x32_bf16 v[88:91], v[12:15], v[56:59], v[88:91]
    v_mfma_f32_16x16x32_bf16 v[92:95], v[12:15], v[60:63], v[92:95]
    s_nop 4
    v_cvt_pk_bf16_f32 v96, v80, v81
    v_cvt_pk_bf16_f32 v97, v82, v83
    v_cvt_pk_bf16_f32 v98, v84, v85
    v_cvt_pk_bf16_f32 v99, v86, v87
    buffer_store_dwordx4 v[96:99], v3, s[12:15], 0 offen sc1
    v_cvt_pk_bf16_f32 v100, v88, v89
    v_cvt_pk_bf16_f32 v101, v90, v91
    v_cvt_pk_bf16_f32 v102, v92, v93
    v_cvt_pk_bf16_f32 v103, v94, v95
    buffer_store_dwordx4 v[100:103], v3, s[12:15], 0 offen offset:256 sc1
KE_FIN:
K_END:
    s_endpgm
.section .rodata,"a"
.p2align 6
.amdhsa_kernel standalone__tensor_product_equiv_tfn__graph_kernel
  .amdhsa_next_free_vgpr 128
  .amdhsa_next_free_sgpr 102
  .amdhsa_accum_offset 128
  .amdhsa_group_segment_fixed_size 0
  .amdhsa_kernarg_size 88
  .amdhsa_user_sgpr_count 2
  .amdhsa_user_sgpr_kernarg_segment_ptr 1
  .amdhsa_system_sgpr_workgroup_id_x 1
  .amdhsa_float_denorm_mode_32 3
.end_amdhsa_kernel
```
